```python
import torch

def _softmax(x, axis=-1):
    return torch.softmax(x, dim=axis)

def _gelu(x):
    return torch.nn.functional.gelu(x, approximate='tanh')

def _silu(x):
    return torch.nn.functional.silu(x)

def _sigmoid(x):
    return torch.sigmoid(x)

def _layernorm(x, axis=-1, eps=1e-05):
    m = x.mean(dim=axis, keepdim=True)
    v = x.var(dim=axis, keepdim=True, unbiased=False)
    return (x - m) / torch.sqrt(v + eps)

def _scatter_add(tgt, idx, src, axis=0):
    return tgt.clone().index_add_(axis, idx, src)

def _segment_sum(src, seg, n):
    out = torch.zeros((n,) + src.shape[1:], dtype=src.dtype)
    return out.index_add_(0, seg, src)

def _pad(x, pw):
    flat = tuple((v for pair in reversed(pw) for v in pair))
    return torch.nn.functional.pad(x, flat)
kernel_name = 'adaLN_cond__sliding_block_cached__mixer_token_mlp__decode'

def setup_inputs():

    _w = lambda a: (lambda t: t.to(torch.bfloat16) if t.is_floating_point() else t)(torch.as_tensor(a))

    def _A_setup():
        B, Sq, D = (1, 1, 640)
        Hq, Hkv, Sk, Dh = (32, 32, 8192, 128)
        assert Hq % Hkv == 0, (Hq, Hkv)
        return {'x': _w((lambda *s: torch.randn(*s, dtype=torch.bfloat16) * 0.05)(B, Sq, D)), 'k_cache': _w((lambda *s: torch.randn(*s, dtype=torch.bfloat16) * 1.6)(B, Hkv, Sk, Dh)), 'v_cache': _w((lambda *s: torch.randn(*s, dtype=torch.bfloat16) * 1.6)(B, Hkv, Sk, Dh)), 'wq': _w((lambda *s: torch.randn(*s, dtype=torch.bfloat16) * 1.6)(D, Hq * Dh) * D ** (-0.5)), 'wo': _w((lambda *s: torch.randn(*s, dtype=torch.bfloat16) * 1.6)(Hq * Dh, D) * (Hq * Dh) ** (-0.5))}
    _A_in = _A_setup()

    def _B_setup():
        B, S, D, F = (1, 1, 640, 1728)
        return {'x': _w((lambda *s: torch.randn(*s, dtype=torch.bfloat16) * 0.05)(B, S, D)), 'w1': _w((lambda *s: torch.randn(*s, dtype=torch.bfloat16) * 0.8)(S, F) * S ** (-0.5)), 'b1': _w((lambda *s: torch.randn(*s, dtype=torch.bfloat16) * 0.8)(F) * 0.02), 'w2': _w((lambda *s: torch.randn(*s, dtype=torch.bfloat16) * 0.8)(F, S) * F ** (-0.5)), 'b2': _w((lambda *s: torch.randn(*s, dtype=torch.bfloat16) * 0.8)(S) * 0.02)}
    _B_in = _B_setup()
    return {'A_x': _A_in['x'], 'A_k_cache': _A_in['k_cache'], 'A_v_cache': _A_in['v_cache'], 'A_wq': _A_in['wq'], 'A_wo': _A_in['wo'], 'B_x': _B_in['x'], 'B_w1': _B_in['w1'], 'B_b1': _B_in['b1'], 'B_w2': _B_in['w2'], 'B_b2': _B_in['b2'], 'c': _w((lambda *s: torch.randn(*s, dtype=torch.bfloat16) * 0.05)(1, 640) * 8.0), 'w_mod': _w((lambda *s: torch.randn(*s, dtype=torch.bfloat16) * 0.05)(640, 6 * 640) * 640 ** (-0.5) * 8.0)}

def reference(A_x, A_k_cache, A_v_cache, A_wq, A_wo, B_x, B_w1, B_b1, B_w2, B_b2, c, w_mod):

    def _A_ref(x, k_cache, v_cache, wq, wo):
        B, Sq, D = x.shape
        Hq, Dh = (32, 128)
        Hkv, Sk = (k_cache.shape[1], k_cache.shape[2])
        W = min(4096, max(256, Sk // 4))
        rep = Hq // Hkv
        q = (lambda x, *d: x.permute(*d))((x @ wq).reshape(B, Sq, Hq, Dh), 0, 2, 1, 3)
        k = (lambda x, n, axis: torch.repeat_interleave(x, n, dim=axis))(k_cache[:, :, Sk - W:, :], rep, axis=1)
        v = (lambda x, n, axis: torch.repeat_interleave(x, n, dim=axis))(v_cache[:, :, Sk - W:, :], rep, axis=1)
        scores = torch.einsum('bhqd,bhkd->bhqk', q, k) * Dh ** (-0.5)
        p = _softmax(scores, axis=-1)
        o = torch.einsum('bhqk,bhkd->bhqd', p, v)
        return (lambda x, *d: x.permute(*d))(o, 0, 2, 1, 3).reshape(B, Sq, Hq * Dh) @ wo

    def _B_ref(x, w1, b1, w2, b2):
        B, S, D = x.shape
        h = _layernorm(x, axis=-1)
        u = torch.einsum('bsd,sf->bdf', h, w1) + b1
        u = _gelu(u)
        y = torch.einsum('bdf,fs->bds', u, w2) + b2
        return (lambda x, *d: x.permute(*d))(y, 0, 2, 1)
    x = A_x
    mod = (_silu(c) @ w_mod).reshape(c.shape[0], 6, 1, -1)
    sa, ca, ga, sb, cb, gb = (mod[:, 0].clone(), mod[:, 1].clone(), mod[:, 2].clone(), mod[:, 3].clone(), mod[:, 4].clone(), mod[:, 5].clone())
    h = _layernorm(x, axis=-1) * (1 + ca) + sa
    x = x + ga * _A_ref(h, A_k_cache, A_v_cache, A_wq, A_wo)
    h = _layernorm(x, axis=-1) * (1 + cb) + sb
    x = x + gb * _B_ref(h, B_w1, B_b1, B_w2, B_b2)
    return x
```

```asm
; @launch grid=(256,1,1) block=(640,1,1) lds=163840
.amdgcn_target "amdgcn-amd-amdhsa--gfx950"
.text
.globl adaLN_cond__sliding_block_cached__mixer_token_mlp__decode_kernel
.p2align 8
.type adaLN_cond__sliding_block_cached__mixer_token_mlp__decode_kernel,@function
adaLN_cond__sliding_block_cached__mixer_token_mlp__decode_kernel:
s_cmp_ge_u32 s2, 256
s_cbranch_scc1 L_end
s_load_dwordx16 s[16:31], s[0:1], 0
s_load_dwordx8 s[32:39], s[0:1], 64
s_load_dwordx4 s[40:43], s[0:1], 96
s_load_dwordx2 s[44:45], s[0:1], 112
v_lshrrev_b32 v1, 6, v0
v_and_b32 v0, 63, v0
s_and_b32 s4, s2, 7
s_lshr_b32 s5, s2, 3
s_and_b32 s6, s5, 3
s_lshr_b32 s7, s5, 2
v_readfirstlane_b32 s8, v1
s_lshl_b32 s10, s4, 2
s_add_u32 s10, s10, s6
s_cmp_lg_u32 s8, 0
s_cbranch_scc1 L_nopf0
s_getpc_b64 s[12:13]
L_pc0:
s_mul_i32 s11, s5, 640
s_add_u32 s12, s12, s11
s_addc_u32 s13, s13, 0
v_lshlrev_b32 v2, 6, v0
s_mov_b64 exec, 1023
global_load_dword v149, v2, s[12:13]
s_mov_b64 exec, -1
L_nopf0:
v_lshrrev_b32 v156, 4, v0
v_and_b32 v157, 15, v0
v_bfe_u32 v158, v0, 2, 2
v_and_b32 v159, 3, v0
s_cmp_lg_u32 s8, 5
s_cbranch_scc1 L_noinit
v_mov_b32 v2, 163008
v_mov_b32 v4, 0
v_mov_b32 v5, 0
v_mov_b32 v6, 0
v_mov_b32 v7, 0
s_mov_b32 exec_lo, 0x00000001
s_mov_b32 exec_hi, 0x00000000
ds_write_b128 v2, v[4:7]
ds_write_b128 v2, v[4:7] offset:16
ds_write_b128 v2, v[4:7] offset:32
s_mov_b64 exec, -1
L_noinit:
s_waitcnt lgkmcnt(0)
s_cmp_lg_u32 s8, 9
s_cbranch_scc1 L_notchain
s_setprio 3
s_mov_b32 s52, s36
s_mov_b32 s53, s37
s_mov_b32 s54, 1280
s_mov_b32 s55, 0x20000
s_mov_b32 s56, s16
s_mov_b32 s57, s17
s_mov_b32 s58, 1280
s_mov_b32 s59, 0x20000
v_lshlrev_b32 v2, 2, v0
s_mul_i32 s11, s4, 160
v_add_u32 v3, s11, v2
buffer_load_dword v6, v3, s[52:55], 0 offen
buffer_load_dword v7, v2, s[56:59], 0 offen offset:0
buffer_load_dword v8, v2, s[56:59], 0 offen offset:256
buffer_load_dword v9, v2, s[56:59], 0 offen offset:512
buffer_load_dword v10, v2, s[56:59], 0 offen offset:768
buffer_load_dword v11, v2, s[56:59], 0 offen offset:1024
s_mul_i32 s11, s7, 160
v_lshl_add_u32 v3, v0, 3, s11
buffer_load_dwordx2 v[12:13], v3, s[56:59], 0 offen
s_mul_i32 s11, s4, 614400
s_lshl_b32 s12, s5, 7
s_add_u32 s11, s11, s12
s_add_u32 s60, s38, s11
s_addc_u32 s61, s39, 0
s_mov_b32 s62, 606848
s_mov_b32 s63, 0x20000
v_lshrrev_b32 v14, 3, v0
v_and_b32 v15, 7, v0
v_bfe_u32 v16, v0, 4, 2
v_lshlrev_b32 v16, 1, v16
v_xor_b32 v15, v15, v16
v_mul_u32_u24 v14, 7680, v14
v_lshl_add_u32 v14, v15, 4, v14
s_cmp_ge_u32 s5, 20
s_cbranch_scc1 L_nocritld
s_mov_b32 m0, 151552
s_mov_b32 s11, 0
buffer_load_dwordx4 v14, s[60:63], s11 offen nt lds
s_mov_b32 m0, 152576
s_mov_b32 s11, 61440
buffer_load_dwordx4 v14, s[60:63], s11 offen nt lds
s_mov_b32 m0, 153600
s_mov_b32 s11, 122880
buffer_load_dwordx4 v14, s[60:63], s11 offen nt lds
s_mov_b32 m0, 154624
s_mov_b32 s11, 184320
buffer_load_dwordx4 v14, s[60:63], s11 offen nt lds
s_mov_b32 m0, 155648
s_mov_b32 s11, 245760
buffer_load_dwordx4 v14, s[60:63], s11 offen nt lds
s_mov_b32 m0, 156672
s_mov_b32 s11, 307200
buffer_load_dwordx4 v14, s[60:63], s11 offen nt lds
s_mov_b32 m0, 157696
s_mov_b32 s11, 368640
buffer_load_dwordx4 v14, s[60:63], s11 offen nt lds
s_mov_b32 m0, 158720
s_mov_b32 s11, 430080
buffer_load_dwordx4 v14, s[60:63], s11 offen nt lds
s_mov_b32 m0, 159744
s_mov_b32 s11, 491520
buffer_load_dwordx4 v14, s[60:63], s11 offen nt lds
s_mov_b32 m0, 160768
s_mov_b32 s11, 552960
buffer_load_dwordx4 v14, s[60:63], s11 offen nt lds
L_nocritld:
s_load_dword s9, s[44:45], 0
s_barrier
s_branch L_chain
L_notchain:
s_cmp_lg_u32 s8, 8
s_cbranch_scc1 L_notloader
s_lshl_b32 s11, s10, 21
s_lshl_b32 s12, s7, 16
s_add_u32 s11, s11, s12
s_add_u32 s11, s11, 1572864
s_add_u32 s60, s18, s11
s_addc_u32 s61, s19, 0
s_mov_b32 s62, 65536
s_mov_b32 s63, 0x20000
s_add_u32 s64, s20, s11
s_addc_u32 s65, s21, 0
s_mov_b32 s66, 65536
s_mov_b32 s67, 0x20000
v_lshlrev_b32 v4, 1, v156
v_xor_b32 v4, v4, v157
v_lshlrev_b32 v4, 4, v4
v_lshl_add_u32 v14, v156, 8, v4
v_xor_b32 v4, v156, v157
v_lshlrev_b32 v4, 4, v4
v_lshl_add_u32 v13, v156, 8, v4
s_mul_i32 s12, s2, 9
s_and_b32 s12, s12, 63
v_mov_b32 v20, 163008
v_mov_b32 v22, 163012
s_mul_i32 s11, s7, 655360
s_lshl_b32 s13, s10, 8
s_add_u32 s11, s11, s13
s_add_u32 s56, s22, s11
s_addc_u32 s57, s23, 0
s_mov_b32 s58, 647424
s_mov_b32 s59, 0x20000
v_lshlrev_b32 v4, 1, v156
v_xor_b32 v4, v4, v157
v_lshlrev_b32 v4, 4, v4
v_lshl_add_u32 v11, v156, 13, v4
v_xor_b32 v12, 0x80, v11
s_barrier
s_mov_b32 m0, 131072
s_mov_b32 s11, 0
buffer_load_dwordx4 v11, s[56:59], s11 offen nt lds
s_mov_b32 m0, 132096
s_mov_b32 s11, 32768
buffer_load_dwordx4 v12, s[56:59], s11 offen nt lds
s_mov_b32 m0, 133120
s_mov_b32 s11, 65536
buffer_load_dwordx4 v11, s[56:59], s11 offen nt lds
s_mov_b32 m0, 134144
s_mov_b32 s11, 98304
buffer_load_dwordx4 v12, s[56:59], s11 offen nt lds
s_mov_b32 m0, 135168
s_mov_b32 s11, 131072
buffer_load_dwordx4 v11, s[56:59], s11 offen nt lds
s_mov_b32 m0, 136192
s_mov_b32 s11, 163840
buffer_load_dwordx4 v12, s[56:59], s11 offen nt lds
s_mov_b32 m0, 137216
s_mov_b32 s11, 196608
buffer_load_dwordx4 v11, s[56:59], s11 offen nt lds
s_mov_b32 m0, 138240
s_mov_b32 s11, 229376
buffer_load_dwordx4 v12, s[56:59], s11 offen nt lds
s_mov_b32 m0, 139264
s_mov_b32 s11, 262144
buffer_load_dwordx4 v11, s[56:59], s11 offen nt lds
s_mov_b32 m0, 140288
s_mov_b32 s11, 294912
buffer_load_dwordx4 v12, s[56:59], s11 offen nt lds
s_mov_b32 m0, 141312
s_mov_b32 s11, 327680
buffer_load_dwordx4 v11, s[56:59], s11 offen nt lds
s_mov_b32 m0, 142336
s_mov_b32 s11, 360448
buffer_load_dwordx4 v12, s[56:59], s11 offen nt lds
s_mov_b32 m0, 143360
s_mov_b32 s11, 393216
buffer_load_dwordx4 v11, s[56:59], s11 offen nt lds
s_mov_b32 m0, 144384
s_mov_b32 s11, 425984
buffer_load_dwordx4 v12, s[56:59], s11 offen nt lds
s_mov_b32 m0, 145408
s_mov_b32 s11, 458752
buffer_load_dwordx4 v11, s[56:59], s11 offen nt lds
s_mov_b32 m0, 146432
s_mov_b32 s11, 491520
buffer_load_dwordx4 v12, s[56:59], s11 offen nt lds
s_mov_b32 m0, 147456
s_mov_b32 s11, 524288
buffer_load_dwordx4 v11, s[56:59], s11 offen nt lds
s_mov_b32 m0, 148480
s_mov_b32 s11, 557056
buffer_load_dwordx4 v12, s[56:59], s11 offen nt lds
s_mov_b32 m0, 149504
s_mov_b32 s11, 589824
buffer_load_dwordx4 v11, s[56:59], s11 offen nt lds
s_mov_b32 m0, 150528
s_mov_b32 s11, 622592
buffer_load_dwordx4 v12, s[56:59], s11 offen nt lds
s_mov_b32 s13, 6
L_ld_1:
s_and_b32 s14, s12, 3
s_lshl_b32 s14, s14, 6
v_xor_b32 v15, s14, v13
s_lshl_b32 s11, s12, 10
s_add_u32 s14, s11, 0
s_mov_b32 m0, s14
s_add_u32 s12, s12, 1
s_and_b32 s12, s12, 63
buffer_load_dwordx4 v15, s[60:63], s11 offen nt lds
s_waitcnt vmcnt(24)
s_and_b32 s14, s12, 3
s_lshl_b32 s14, s14, 6
v_xor_b32 v15, s14, v13
s_lshl_b32 s11, s12, 10
s_add_u32 s14, s11, 0
s_mov_b32 m0, s14
s_add_u32 s12, s12, 1
s_and_b32 s12, s12, 63
buffer_load_dwordx4 v15, s[60:63], s11 offen nt lds
s_waitcnt vmcnt(24)
s_and_b32 s14, s12, 3
s_lshl_b32 s14, s14, 6
v_xor_b32 v15, s14, v13
s_lshl_b32 s11, s12, 10
s_add_u32 s14, s11, 0
s_mov_b32 m0, s14
s_add_u32 s12, s12, 1
s_and_b32 s12, s12, 63
buffer_load_dwordx4 v15, s[60:63], s11 offen nt lds
s_waitcnt vmcnt(24)
s_and_b32 s14, s12, 3
s_lshl_b32 s14, s14, 6
v_xor_b32 v15, s14, v13
s_lshl_b32 s11, s12, 10
s_add_u32 s14, s11, 0
s_mov_b32 m0, s14
s_add_u32 s12, s12, 1
s_and_b32 s12, s12, 63
buffer_load_dwordx4 v15, s[60:63], s11 offen nt lds
s_waitcnt vmcnt(24)
s_sub_u32 s13, s13, 1
s_cmp_lg_u32 s13, 0
s_cbranch_scc1 L_ld_1
v_mov_b32 v21, 2
ds_write_b32 v20, v21
s_mov_b32 s13, 1
L_ld_2:
s_and_b32 s14, s12, 3
s_lshl_b32 s14, s14, 6
v_xor_b32 v15, s14, v13
s_lshl_b32 s11, s12, 10
s_add_u32 s14, s11, 0
s_mov_b32 m0, s14
s_add_u32 s12, s12, 1
s_and_b32 s12, s12, 63
buffer_load_dwordx4 v15, s[60:63], s11 offen nt lds
s_waitcnt vmcnt(24)
s_and_b32 s14, s12, 3
s_lshl_b32 s14, s14, 6
v_xor_b32 v15, s14, v13
s_lshl_b32 s11, s12, 10
s_add_u32 s14, s11, 0
s_mov_b32 m0, s14
s_add_u32 s12, s12, 1
s_and_b32 s12, s12, 63
buffer_load_dwordx4 v15, s[60:63], s11 offen nt lds
s_waitcnt vmcnt(24)
s_and_b32 s14, s12, 3
s_lshl_b32 s14, s14, 6
v_xor_b32 v15, s14, v13
s_lshl_b32 s11, s12, 10
s_add_u32 s14, s11, 0
s_mov_b32 m0, s14
s_add_u32 s12, s12, 1
s_and_b32 s12, s12, 63
buffer_load_dwordx4 v15, s[60:63], s11 offen nt lds
s_waitcnt vmcnt(24)
s_and_b32 s14, s12, 3
s_lshl_b32 s14, s14, 6
v_xor_b32 v15, s14, v13
s_lshl_b32 s11, s12, 10
s_add_u32 s14, s11, 0
s_mov_b32 m0, s14
s_add_u32 s12, s12, 1
s_and_b32 s12, s12, 63
buffer_load_dwordx4 v15, s[60:63], s11 offen nt lds
s_waitcnt vmcnt(24)
s_sub_u32 s13, s13, 1
s_cmp_lg_u32 s13, 0
s_cbranch_scc1 L_ld_2
v_mov_b32 v21, 3
ds_write_b32 v20, v21
s_mov_b32 s13, 9
L_ld_3:
s_and_b32 s14, s12, 3
s_lshl_b32 s14, s14, 6
v_xor_b32 v15, s14, v13
s_lshl_b32 s11, s12, 10
s_add_u32 s14, s11, 0
s_mov_b32 m0, s14
s_add_u32 s12, s12, 1
s_and_b32 s12, s12, 63
buffer_load_dwordx4 v15, s[60:63], s11 offen nt lds
s_waitcnt vmcnt(24)
s_and_b32 s14, s12, 3
s_lshl_b32 s14, s14, 6
v_xor_b32 v15, s14, v13
s_lshl_b32 s11, s12, 10
s_add_u32 s14, s11, 0
s_mov_b32 m0, s14
s_add_u32 s12, s12, 1
s_and_b32 s12, s12, 63
buffer_load_dwordx4 v15, s[60:63], s11 offen nt lds
s_waitcnt vmcnt(24)
s_and_b32 s14, s12, 3
s_lshl_b32 s14, s14, 6
v_xor_b32 v15, s14, v13
s_lshl_b32 s11, s12, 10
s_add_u32 s14, s11, 0
s_mov_b32 m0, s14
s_add_u32 s12, s12, 1
s_and_b32 s12, s12, 63
buffer_load_dwordx4 v15, s[60:63], s11 offen nt lds
s_waitcnt vmcnt(24)
s_and_b32 s14, s12, 3
s_lshl_b32 s14, s14, 6
v_xor_b32 v15, s14, v13
s_lshl_b32 s11, s12, 10
s_add_u32 s14, s11, 0
s_mov_b32 m0, s14
s_add_u32 s12, s12, 1
s_and_b32 s12, s12, 63
buffer_load_dwordx4 v15, s[60:63], s11 offen nt lds
s_waitcnt vmcnt(24)
s_sub_u32 s13, s13, 1
s_cmp_lg_u32 s13, 0
s_cbranch_scc1 L_ld_3
s_mov_b32 s13, 6
L_ld_4:
s_and_b32 s14, s12, 2
s_lshl_b32 s14, s14, 6
v_xor_b32 v15, s14, v14
s_lshl_b32 s11, s12, 10
s_add_u32 s14, s11, 65536
s_mov_b32 m0, s14
s_add_u32 s12, s12, 1
s_and_b32 s12, s12, 63
buffer_load_dwordx4 v15, s[64:67], s11 offen nt lds
s_waitcnt vmcnt(24)
s_and_b32 s14, s12, 2
s_lshl_b32 s14, s14, 6
v_xor_b32 v15, s14, v14
s_lshl_b32 s11, s12, 10
s_add_u32 s14, s11, 65536
s_mov_b32 m0, s14
s_add_u32 s12, s12, 1
s_and_b32 s12, s12, 63
buffer_load_dwordx4 v15, s[64:67], s11 offen nt lds
s_waitcnt vmcnt(24)
s_and_b32 s14, s12, 2
s_lshl_b32 s14, s14, 6
v_xor_b32 v15, s14, v14
s_lshl_b32 s11, s12, 10
s_add_u32 s14, s11, 65536
s_mov_b32 m0, s14
s_add_u32 s12, s12, 1
s_and_b32 s12, s12, 63
buffer_load_dwordx4 v15, s[64:67], s11 offen nt lds
s_waitcnt vmcnt(24)
s_and_b32 s14, s12, 2
s_lshl_b32 s14, s14, 6
v_xor_b32 v15, s14, v14
s_lshl_b32 s11, s12, 10
s_add_u32 s14, s11, 65536
s_mov_b32 m0, s14
s_add_u32 s12, s12, 1
s_and_b32 s12, s12, 63
buffer_load_dwordx4 v15, s[64:67], s11 offen nt lds
s_waitcnt vmcnt(24)
s_sub_u32 s13, s13, 1
s_cmp_lg_u32 s13, 0
s_cbranch_scc1 L_ld_4
v_mov_b32 v21, 4
ds_write_b32 v20, v21
s_cmp_ge_u32 s5, 20
s_cbranch_scc1 L_ld_mr
s_mul_i32 s11, s4, 655360
s_lshl_b32 s13, s5, 6
s_add_u32 s11, s11, s13
s_add_u32 s52, s24, s11
s_addc_u32 s53, s25, 0
s_mov_b32 s54, 654144
s_mov_b32 s55, 0x20000
v_lshrrev_b32 v2, 2, v0
v_mul_u32_u24 v2, 1280, v2
v_lshrrev_b32 v3, 5, v0
v_lshlrev_b32 v3, 1, v3
v_xor_b32 v3, v3, v159
v_lshl_add_u32 v16, v3, 4, v2
v_mov_b32 v17, v16
s_mov_b32 s46, 32
s_mov_b32 s47, 20480
s_branch L_ld_go
L_ld_mr:
s_sub_u32 s13, s5, 20
s_lshl_b32 s13, s13, 3
s_add_u32 s13, s13, s4
s_and_b32 s14, s13, 1
s_lshr_b32 s13, s13, 1
s_mul_i32 s11, s14, 2457600
s_lshl_b32 s15, s13, 7
s_add_u32 s11, s11, s15
s_add_u32 s11, s11, 2560
s_cmp_ge_u32 s5, 30
s_cselect_b32 s11, 0, s11
s_cselect_b32 s46, 0, 40
s_mov_b32 s47, 61440
s_add_u32 s52, s38, s11
s_addc_u32 s53, s39, 0
s_mov_b32 s54, 2450048
s_mov_b32 s55, 0x20000
v_lshrrev_b32 v2, 3, v0
v_and_b32 v3, 7, v0
v_bfe_u32 v4, v0, 4, 1
v_lshlrev_b32 v4, 1, v4
v_xor_b32 v3, v3, v4
v_mul_u32_u24 v2, 7680, v2
v_lshl_add_u32 v16, v3, 4, v2
v_xor_b32 v17, 64, v16
L_ld_go:
s_mov_b32 s74, 0
s_mov_b32 s75, 0
s_mov_b32 s13, 6
L_lq_5:
ds_read_b32 v23, v22
s_waitcnt lgkmcnt(0)
v_readfirstlane_b32 s14, v23
s_nop 0
s_cmp_lg_u32 s14, 0
s_cbranch_scc1 L_lqf_6
s_and_b32 s14, s12, 2
s_lshl_b32 s14, s14, 6
v_xor_b32 v15, s14, v14
s_lshl_b32 s11, s12, 10
s_add_u32 s14, s11, 65536
s_mov_b32 m0, s14
s_add_u32 s12, s12, 1
s_and_b32 s12, s12, 63
buffer_load_dwordx4 v15, s[64:67], s11 offen nt lds
s_waitcnt vmcnt(24)
s_and_b32 s14, s12, 2
s_lshl_b32 s14, s14, 6
v_xor_b32 v15, s14, v14
s_lshl_b32 s11, s12, 10
s_add_u32 s14, s11, 65536
s_mov_b32 m0, s14
s_add_u32 s12, s12, 1
s_and_b32 s12, s12, 63
buffer_load_dwordx4 v15, s[64:67], s11 offen nt lds
s_waitcnt vmcnt(24)
s_and_b32 s14, s12, 2
s_lshl_b32 s14, s14, 6
v_xor_b32 v15, s14, v14
s_lshl_b32 s11, s12, 10
s_add_u32 s14, s11, 65536
s_mov_b32 m0, s14
s_add_u32 s12, s12, 1
s_and_b32 s12, s12, 63
buffer_load_dwordx4 v15, s[64:67], s11 offen nt lds
s_waitcnt vmcnt(24)
s_and_b32 s14, s12, 2
s_lshl_b32 s14, s14, 6
v_xor_b32 v15, s14, v14
s_lshl_b32 s11, s12, 10
s_add_u32 s14, s11, 65536
s_mov_b32 m0, s14
s_add_u32 s12, s12, 1
s_and_b32 s12, s12, 63
buffer_load_dwordx4 v15, s[64:67], s11 offen nt lds
s_waitcnt vmcnt(24)
s_sub_u32 s13, s13, 1
s_cmp_lg_u32 s13, 0
s_cbranch_scc1 L_lq_5
s_branch L_lqd_7
L_lqf_6:
s_and_b32 s14, s12, 2
s_lshl_b32 s14, s14, 6
v_xor_b32 v15, s14, v14
s_lshl_b32 s11, s12, 10
s_add_u32 s14, s11, 65536
s_mov_b32 m0, s14
s_add_u32 s12, s12, 1
s_and_b32 s12, s12, 63
buffer_load_dwordx4 v15, s[64:67], s11 offen nt lds
s_waitcnt vmcnt(40)
s_and_b32 s14, s12, 2
s_lshl_b32 s14, s14, 6
v_xor_b32 v15, s14, v14
s_lshl_b32 s11, s12, 10
s_add_u32 s14, s11, 65536
s_mov_b32 m0, s14
s_add_u32 s12, s12, 1
s_and_b32 s12, s12, 63
buffer_load_dwordx4 v15, s[64:67], s11 offen nt lds
s_waitcnt vmcnt(40)
s_and_b32 s14, s12, 2
s_lshl_b32 s14, s14, 6
v_xor_b32 v15, s14, v14
s_lshl_b32 s11, s12, 10
s_add_u32 s14, s11, 65536
s_mov_b32 m0, s14
s_add_u32 s12, s12, 1
s_and_b32 s12, s12, 63
buffer_load_dwordx4 v15, s[64:67], s11 offen nt lds
s_waitcnt vmcnt(40)
s_and_b32 s14, s12, 2
s_lshl_b32 s14, s14, 6
v_xor_b32 v15, s14, v14
s_lshl_b32 s11, s12, 10
s_add_u32 s14, s11, 65536
s_mov_b32 m0, s14
s_add_u32 s12, s12, 1
s_and_b32 s12, s12, 63
buffer_load_dwordx4 v15, s[64:67], s11 offen nt lds
s_waitcnt vmcnt(40)
s_sub_u32 s13, s13, 1
s_cmp_lg_u32 s13, 0
s_cbranch_scc1 L_lqf_6
L_lqd_7:
s_mov_b32 s77, 0
v_mov_b32 v3, 163016
L_lw_8:
ds_read_b32 v2, v3
s_waitcnt lgkmcnt(0)
v_readfirstlane_b32 s11, v2
s_nop 0
s_cmp_ge_u32 s11, 8
s_cbranch_scc1 L_lwd_10
s_add_u32 s77, s77, 1
s_cmp_lt_u32 s77, 1600000
s_cbranch_scc1 L_lw_8
L_lwd_10:
s_min_u32 s76, s46, 12
s_sub_u32 s77, s46, s76
s_cmp_eq_u32 s76, 0
s_cbranch_scc1 L_lld_12
s_lshr_b32 s13, s76, 1
L_ll_11:
s_mov_b32 m0, s75
s_add_u32 s75, s75, 1024
buffer_load_dwordx4 v16, s[52:55], s74 offen nt lds
s_add_u32 s74, s74, s47
s_waitcnt vmcnt(40)
s_mov_b32 m0, s75
s_add_u32 s75, s75, 1024
buffer_load_dwordx4 v17, s[52:55], s74 offen nt lds
s_add_u32 s74, s74, s47
s_waitcnt vmcnt(40)
s_sub_u32 s13, s13, 1
s_cmp_lg_u32 s13, 0
s_cbranch_scc1 L_ll_11
L_lld_12:
s_mov_b32 s13, 4
L_ld_13:
s_and_b32 s14, s12, 2
s_lshl_b32 s14, s14, 6
v_xor_b32 v15, s14, v14
s_lshl_b32 s11, s12, 10
s_add_u32 s14, s11, 65536
s_mov_b32 m0, s14
s_add_u32 s12, s12, 1
s_and_b32 s12, s12, 63
buffer_load_dwordx4 v15, s[64:67], s11 offen nt lds
s_waitcnt vmcnt(40)
s_and_b32 s14, s12, 2
s_lshl_b32 s14, s14, 6
v_xor_b32 v15, s14, v14
s_lshl_b32 s11, s12, 10
s_add_u32 s14, s11, 65536
s_mov_b32 m0, s14
s_add_u32 s12, s12, 1
s_and_b32 s12, s12, 63
buffer_load_dwordx4 v15, s[64:67], s11 offen nt lds
s_waitcnt vmcnt(40)
s_and_b32 s14, s12, 2
s_lshl_b32 s14, s14, 6
v_xor_b32 v15, s14, v14
s_lshl_b32 s11, s12, 10
s_add_u32 s14, s11, 65536
s_mov_b32 m0, s14
s_add_u32 s12, s12, 1
s_and_b32 s12, s12, 63
buffer_load_dwordx4 v15, s[64:67], s11 offen nt lds
s_waitcnt vmcnt(40)
s_and_b32 s14, s12, 2
s_lshl_b32 s14, s14, 6
v_xor_b32 v15, s14, v14
s_lshl_b32 s11, s12, 10
s_add_u32 s14, s11, 65536
s_mov_b32 m0, s14
s_add_u32 s12, s12, 1
s_and_b32 s12, s12, 63
buffer_load_dwordx4 v15, s[64:67], s11 offen nt lds
s_waitcnt vmcnt(40)
s_sub_u32 s13, s13, 1
s_cmp_lg_u32 s13, 0
s_cbranch_scc1 L_ld_13
s_cmp_eq_u32 s77, 0
s_cbranch_scc1 L_lld_15
s_lshr_b32 s13, s77, 1
L_ll_14:
s_mov_b32 m0, s75
s_add_u32 s75, s75, 1024
buffer_load_dwordx4 v16, s[52:55], s74 offen nt lds
s_add_u32 s74, s74, s47
s_waitcnt vmcnt(40)
s_mov_b32 m0, s75
s_add_u32 s75, s75, 1024
buffer_load_dwordx4 v17, s[52:55], s74 offen nt lds
s_add_u32 s74, s74, s47
s_waitcnt vmcnt(40)
s_sub_u32 s13, s13, 1
s_cmp_lg_u32 s13, 0
s_cbranch_scc1 L_ll_14
L_lld_15:
s_cmp_eq_u32 s46, 32
s_cbranch_scc1 L_lv_16
s_cmp_eq_u32 s46, 40
s_cbranch_scc1 L_lw_17
s_waitcnt vmcnt(0)
v_mov_b32 v21, 6
ds_write_b32 v20, v21
s_waitcnt vmcnt(0)
v_mov_b32 v21, 7
ds_write_b32 v20, v21
s_waitcnt lgkmcnt(0)
s_endpgm
L_lv_16:
s_waitcnt vmcnt(20)
v_mov_b32 v21, 6
ds_write_b32 v20, v21
s_waitcnt vmcnt(0)
v_mov_b32 v21, 7
ds_write_b32 v20, v21
s_waitcnt lgkmcnt(0)
s_endpgm
L_lw_17:
s_waitcnt vmcnt(28)
v_mov_b32 v21, 6
ds_write_b32 v20, v21
s_waitcnt vmcnt(0)
v_mov_b32 v21, 7
ds_write_b32 v20, v21
s_waitcnt lgkmcnt(0)
s_endpgm
L_notloader:
s_barrier
s_load_dword s9, s[44:45], 0
s_mov_b32 s48, s44
s_mov_b32 s49, s45
s_mov_b32 s50, 1835008
s_mov_b32 s51, 0x20000
v_mov_b32 v1, 0xff
s_mov_b32 s72, 0x0c0c0400
s_mov_b32 s73, 0x04000c0c
s_cmp_lg_u32 s8, 7
s_cbranch_scc1 L_notlb
s_lshl_b32 s11, s10, 21
s_lshl_b32 s12, s7, 16
s_add_u32 s11, s11, s12
s_add_u32 s11, s11, 1572864
s_add_u32 s52, s20, s11
s_addc_u32 s53, s21, 0
s_mov_b32 s54, 65536
s_mov_b32 s55, 0x20000
s_mul_i32 s11, s4, 655360
s_add_u32 s56, s24, s11
s_addc_u32 s57, s25, 0
s_mov_b32 s58, 655360
s_mov_b32 s59, 0x20000
s_mov_b32 s60, s40
s_mov_b32 s61, s41
s_mov_b32 s62, 1280
s_mov_b32 s63, 0x20000
v_mov_b32 v2, 0
s_mov_b32 exec_lo, 0x00000001
s_mov_b32 exec_hi, 0x00000000
buffer_load_dword v149, v2, s[52:55], 0 offen nt
buffer_load_dword v149, v2, s[56:59], 0 offen nt
buffer_load_dword v149, v2, s[60:63], 0 offen
s_mov_b64 exec, -1
L_notlb:
s_cmp_lg_u32 s8, 6
s_cbranch_scc1 L_nopw
s_lshl_b32 s11, s4, 14
s_lshl_b32 s12, s5, 9
s_add_u32 s11, s11, s12
v_and_b32 v2, 3, v0
v_lshlrev_b32 v2, 7, v2
v_add_u32 v2, s11, v2
s_mov_b32 s12, 172032
s_mov_b32 s13, 303104
s_mov_b32 exec_lo, 0x0000000f
s_mov_b32 exec_hi, 0x00000000
buffer_load_dword v149, v2, s[48:51], s12 offen sc1
buffer_load_dword v149, v2, s[48:51], s13 offen sc1
s_mov_b64 exec, -1
s_cmp_ge_u32 s5, 20
s_cbranch_scc1 L_nopw
s_mul_i32 s11, s4, 10240
s_lshl_b32 s12, s5, 7
s_add_u32 s11, s11, s12
s_add_u32 s11, s11, 434176
v_mul_u32_u24 v2, 2560, v0
s_mov_b32 exec_lo, 0x0000000f
s_mov_b32 exec_hi, 0x00000000
buffer_load_dword v149, v2, s[48:51], s11 offen sc1
s_mov_b64 exec, -1
s_cmp_lg_u32 s5, 1
s_cbranch_scc1 L_nopw
v_lshlrev_b32 v2, 7, v0
s_lshl_b32 s11, s4, 9
s_add_u32 s11, s11, 131072
s_mov_b32 exec_lo, 0x0000000f
s_mov_b32 exec_hi, 0x00000000
buffer_load_dword v149, v2, s[48:51], s11 offen sc1
s_mov_b64 exec, -1
L_nopw:
s_waitcnt lgkmcnt(0)
s_add_u32 s9, s9, 0x01010101
s_and_b32 s68, s9, 0xff
s_bfe_u32 s69, s9, 0x80008
s_bfe_u32 s70, s9, 0x80010
s_lshr_b32 s71, s9, 24
s_mov_b32 s77, 0
v_mov_b32 v3, 163008
L_lw_18:
ds_read_b32 v2, v3
s_waitcnt lgkmcnt(0)
v_readfirstlane_b32 s11, v2
s_nop 0
s_cmp_ge_u32 s11, 2
s_cbranch_scc1 L_lwd_20
s_sleep 4
s_add_u32 s77, s77, 1
s_cmp_lt_u32 s77, 1600000
s_cbranch_scc1 L_lw_18
L_lwd_20:
v_lshrrev_b32 v16, 1, v159
v_lshlrev_b32 v16, 4, v16
v_and_b32 v17, 1, v159
v_lshl_add_u32 v16, v17, 3, v16
v_lshl_add_u32 v17, v156, 2, v158
v_and_b32 v19, 7, v17
v_lshlrev_b32 v19, 5, v19
v_xor_b32 v19, v19, v16
v_lshl_add_u32 v19, v17, 8, v19
s_lshl_b32 s11, s8, 5
v_xor_b32 v19, s11, v19
v_add_u32 v19, 131072, v19
ds_read_b64_tr_b16 v[84:85], v19 offset:0
ds_read_b64_tr_b16 v[86:87], v19 offset:4096
ds_read_b64_tr_b16 v[88:89], v19 offset:8192
ds_read_b64_tr_b16 v[90:91], v19 offset:12288
ds_read_b64_tr_b16 v[92:93], v19 offset:16384
s_lshl_b32 s12, s4, 14
s_lshl_b32 s13, s6, 12
s_add_u32 s12, s12, s13
s_lshl_b32 s13, s7, 9
s_add_u32 s12, s12, s13
s_lshl_b32 s13, s8, 6
s_add_u32 s12, s12, s13
s_add_u32 s12, s12, 172032
v_lshlrev_b32 v94, 4, v156
v_add_u32 v94, s12, v94
v_lshlrev_b32 v95, 3, v156
v_add_u32 v95, 162560, v95
s_lshl_b32 s11, s8, 9
v_lshl_add_u32 v2, v0, 3, s11
s_mov_b32 s52, s28
s_mov_b32 s53, s29
s_mov_b32 s54, 3456
s_mov_b32 s55, 0x20000
s_mov_b32 s60, s30
s_mov_b32 s61, s31
s_mov_b32 s62, 3456
s_mov_b32 s63, 0x20000
s_mov_b32 s64, s32
s_mov_b32 s65, s33
s_mov_b32 s66, 3456
s_mov_b32 s67, 0x20000
buffer_load_dwordx2 v[160:161], v2, s[52:55], 0 offen
buffer_load_dwordx2 v[162:163], v2, s[60:63], 0 offen
buffer_load_dwordx2 v[164:165], v2, s[64:67], 0 offen
s_mov_b32 s52, s34
s_mov_b32 s53, s35
s_mov_b32 s54, 2
s_mov_b32 s55, 0x20000
v_mov_b32 v2, 0
buffer_load_ushort v166, v2, s[52:55], 0 offen
s_waitcnt vmcnt(0)
v_lshlrev_b32 v112, 16, v160
v_and_b32 v113, 0xffff0000, v160
v_lshlrev_b32 v116, 16, v162
v_and_b32 v117, 0xffff0000, v162
v_lshlrev_b32 v120, 16, v164
v_and_b32 v121, 0xffff0000, v164
v_lshlrev_b32 v114, 16, v161
v_and_b32 v115, 0xffff0000, v161
v_lshlrev_b32 v118, 16, v163
v_and_b32 v119, 0xffff0000, v163
v_lshlrev_b32 v122, 16, v165
v_and_b32 v123, 0xffff0000, v165
v_lshlrev_b32 v166, 16, v166
s_sub_u32 s11, s5, 20
s_cmp_gt_u32 s11, 9
s_cbranch_scc1 L_nosilu
s_cmp_ge_u32 s8, 5
s_cbranch_scc1 L_nosilu
s_lshl_b32 s12, s11, 3
s_add_u32 s12, s12, s4
s_and_b32 s14, s12, 1
s_mul_i32 s13, s14, 320
s_lshl_b32 s15, s8, 6
s_add_u32 s13, s13, s15
s_mov_b32 s52, s36
s_mov_b32 s53, s37
s_mov_b32 s54, 1280
s_mov_b32 s55, 0x20000
s_lshl_b32 s13, s13, 1
v_lshl_add_u32 v3, v0, 2, s13
buffer_load_dword v154, v3, s[52:55], 0 offen
s_waitcnt vmcnt(0)
v_lshlrev_b32 v14, 16, v154
v_and_b32 v15, 0xffff0000, v154
v_mul_f32 v16, 0xbfb8aa3b, v14
v_exp_f32 v16, v16
s_nop 0
v_add_f32 v16, 1.0, v16
v_rcp_f32 v16, v16
s_nop 0
v_mul_f32 v14, v14, v16
v_mul_f32 v16, 0xbfb8aa3b, v15
v_exp_f32 v16, v16
s_nop 0
v_add_f32 v16, 1.0, v16
v_rcp_f32 v16, v16
s_nop 0
v_mul_f32 v15, v15, v16
v_cvt_pk_bf16_f32 v14, v14, v15
s_lshl_b32 s11, s8, 7
s_add_u32 s11, s11, 163136
v_lshl_add_u32 v3, v0, 2, s11
s_mov_b32 exec_lo, 0xffffffff
s_mov_b32 exec_hi, 0x00000000
ds_write_b32 v3, v14
s_mov_b64 exec, -1
L_nosilu:
s_mov_b32 s77, 0
v_mov_b32 v3, 163020
L_lw_21:
ds_read_b32 v2, v3
s_waitcnt lgkmcnt(0)
v_readfirstlane_b32 s11, v2
s_nop 0
s_cmp_ge_u32 s11, 1
s_cbranch_scc1 L_lwd_23
s_add_u32 s77, s77, 1
s_cmp_lt_u32 s77, 1600000
s_cbranch_scc1 L_lw_21
L_lwd_23:
ds_read_b64 v[2:3], v95 offset:0
ds_read_b64 v[4:5], v95 offset:32
ds_read_b64 v[6:7], v95 offset:64
ds_read_b64 v[8:9], v95 offset:96
ds_read_b64 v[10:11], v95 offset:128
s_waitcnt lgkmcnt(0)
v_mfma_f32_16x16x16_bf16 v[124:127], v[84:85], v[2:3], 0
v_mfma_f32_16x16x16_bf16 v[124:127], v[86:87], v[4:5], v[124:127]
v_mfma_f32_16x16x16_bf16 v[124:127], v[88:89], v[6:7], v[124:127]
v_mfma_f32_16x16x16_bf16 v[124:127], v[90:91], v[8:9], v[124:127]
v_mfma_f32_16x16x16_bf16 v[124:127], v[92:93], v[10:11], v[124:127]
s_mov_b32 exec_lo, 0x00010001
s_mov_b32 exec_hi, 0x00010001
s_nop 5
v_bfi_b32 v124, v1, s68, v124
v_bfi_b32 v125, v1, s69, v125
v_bfi_b32 v126, v1, s70, v126
v_bfi_b32 v127, v1, s71, v127
buffer_store_dwordx4 v[124:127], v94, s[48:51], 0 offen
v_mov_b32 v128, v94
s_waitcnt vmcnt(0)
s_mov_b32 exec_lo, 0x00000001
s_mov_b32 exec_hi, 0x00000000
v_mov_b32 v2, 163032
v_mov_b32 v3, 1
ds_add_u32 v2, v3
s_mov_b64 exec, -1
s_branch L_kv
L_chain:
s_mov_b32 s48, s44
s_mov_b32 s49, s45
s_mov_b32 s50, 1835008
s_mov_b32 s51, 0x20000
v_mov_b32 v1, 0xff
s_mov_b32 s72, 0x0c0c0400
s_mov_b32 s73, 0x04000c0c
s_cmp_ge_u32 s5, 20
s_cbranch_scc1 L_ch_w0
s_waitcnt vmcnt(10) lgkmcnt(0)
s_branch L_ch_w1
L_ch_w0:
s_waitcnt vmcnt(0) lgkmcnt(0)
L_ch_w1:
s_add_u32 s9, s9, 0x01010101
s_and_b32 s68, s9, 0xff
s_bfe_u32 s69, s9, 0x80008
s_bfe_u32 s70, s9, 0x80010
s_lshr_b32 s71, s9, 24
v_lshlrev_b32 v14, 16, v6
v_and_b32 v15, 0xffff0000, v6
v_mul_f32 v16, 0xbfb8aa3b, v14
v_exp_f32 v16, v16
s_nop 0
v_add_f32 v16, 1.0, v16
v_rcp_f32 v16, v16
s_nop 0
v_mul_f32 v14, v14, v16
v_mul_f32 v16, 0xbfb8aa3b, v15
v_exp_f32 v16, v16
s_nop 0
v_add_f32 v16, 1.0, v16
v_rcp_f32 v16, v16
s_nop 0
v_mul_f32 v15, v15, v16
v_cvt_pk_bf16_f32 v14, v14, v15
v_add_u32 v3, 161792, v2
s_mov_b32 exec_lo, 0xffffffff
s_mov_b32 exec_hi, 0x000000ff
ds_write_b32 v3, v14
s_mov_b64 exec, -1
v_lshrrev_b32 v16, 1, v159
v_lshlrev_b32 v16, 4, v16
v_and_b32 v17, 1, v159
v_lshl_add_u32 v16, v17, 3, v16
v_lshl_add_u32 v17, v156, 2, v158
s_cmp_ge_u32 s5, 20
s_cbranch_scc1 L_nocrit
v_lshlrev_b32 v18, 3, v156
v_add_u32 v18, 161792, v18
v_bfe_u32 v19, v17, 1, 2
v_lshlrev_b32 v19, 5, v19
v_xor_b32 v19, v19, v16
v_lshl_add_u32 v19, v17, 7, v19
v_add_u32 v19, 151552, v19
ds_read_b64 v[20:21], v18 offset:0
ds_read_b64 v[22:23], v18 offset:32
ds_read_b64 v[24:25], v18 offset:64
ds_read_b64 v[26:27], v18 offset:96
ds_read_b64 v[28:29], v18 offset:128
s_waitcnt vmcnt(0)
ds_read_b64_tr_b16 v[30:31], v19 offset:0
ds_read_b64_tr_b16 v[32:33], v19 offset:2048
ds_read_b64_tr_b16 v[34:35], v19 offset:4096
ds_read_b64_tr_b16 v[36:37], v19 offset:6144
ds_read_b64_tr_b16 v[38:39], v19 offset:8192
v_xor_b32 v18, 32, v19
ds_read_b64_tr_b16 v[40:41], v18 offset:0
ds_read_b64_tr_b16 v[42:43], v18 offset:2048
ds_read_b64_tr_b16 v[44:45], v18 offset:4096
ds_read_b64_tr_b16 v[46:47], v18 offset:6144
ds_read_b64_tr_b16 v[48:49], v18 offset:8192
v_xor_b32 v18, 64, v19
ds_read_b64_tr_b16 v[50:51], v18 offset:0
ds_read_b64_tr_b16 v[52:53], v18 offset:2048
ds_read_b64_tr_b16 v[54:55], v18 offset:4096
ds_read_b64_tr_b16 v[56:57], v18 offset:6144
ds_read_b64_tr_b16 v[58:59], v18 offset:8192
v_xor_b32 v18, 96, v19
ds_read_b64_tr_b16 v[60:61], v18 offset:0
ds_read_b64_tr_b16 v[62:63], v18 offset:2048
ds_read_b64_tr_b16 v[64:65], v18 offset:4096
ds_read_b64_tr_b16 v[66:67], v18 offset:6144
ds_read_b64_tr_b16 v[68:69], v18 offset:8192
s_waitcnt lgkmcnt(15)
v_mfma_f32_16x16x16_bf16 v[70:73], v[30:31], v[20:21], 0
v_mfma_f32_16x16x16_bf16 v[70:73], v[32:33], v[22:23], v[70:73]
v_mfma_f32_16x16x16_bf16 v[70:73], v[34:35], v[24:25], v[70:73]
v_mfma_f32_16x16x16_bf16 v[70:73], v[36:37], v[26:27], v[70:73]
v_mfma_f32_16x16x16_bf16 v[70:73], v[38:39], v[28:29], v[70:73]
s_waitcnt lgkmcnt(10)
v_mfma_f32_16x16x16_bf16 v[74:77], v[40:41], v[20:21], 0
v_mfma_f32_16x16x16_bf16 v[74:77], v[42:43], v[22:23], v[74:77]
v_mfma_f32_16x16x16_bf16 v[74:77], v[44:45], v[24:25], v[74:77]
v_mfma_f32_16x16x16_bf16 v[74:77], v[46:47], v[26:27], v[74:77]
v_mfma_f32_16x16x16_bf16 v[74:77], v[48:49], v[28:29], v[74:77]
s_waitcnt lgkmcnt(5)
v_mfma_f32_16x16x16_bf16 v[78:81], v[50:51], v[20:21], 0
v_mfma_f32_16x16x16_bf16 v[78:81], v[52:53], v[22:23], v[78:81]
v_mfma_f32_16x16x16_bf16 v[78:81], v[54:55], v[24:25], v[78:81]
v_mfma_f32_16x16x16_bf16 v[78:81], v[56:57], v[26:27], v[78:81]
v_mfma_f32_16x16x16_bf16 v[78:81], v[58:59], v[28:29], v[78:81]
s_waitcnt lgkmcnt(0)
v_mfma_f32_16x16x16_bf16 v[82:85], v[60:61], v[20:21], 0
v_mfma_f32_16x16x16_bf16 v[82:85], v[62:63], v[22:23], v[82:85]
v_mfma_f32_16x16x16_bf16 v[82:85], v[64:65], v[24:25], v[82:85]
v_mfma_f32_16x16x16_bf16 v[82:85], v[66:67], v[26:27], v[82:85]
v_mfma_f32_16x16x16_bf16 v[82:85], v[68:69], v[28:29], v[82:85]
s_mul_i32 s11, s4, 5120
s_lshl_b32 s12, s5, 8
s_add_u32 s11, s11, s12
s_add_u32 s11, s11, 4096
v_lshlrev_b32 v18, 6, v157
v_lshl_add_u32 v18, v156, 4, v18
s_mov_b32 exec_lo, 0x00020002
s_mov_b32 exec_hi, 0x00020002
v_mov_b32 v70, v74
v_mov_b32 v71, v75
v_mov_b32 v72, v76
v_mov_b32 v73, v77
s_mov_b32 exec_lo, 0x00040004
s_mov_b32 exec_hi, 0x00040004
v_mov_b32 v70, v78
v_mov_b32 v71, v79
v_mov_b32 v72, v80
v_mov_b32 v73, v81
s_mov_b32 exec_lo, 0x00080008
s_mov_b32 exec_hi, 0x00080008
v_mov_b32 v70, v82
v_mov_b32 v71, v83
v_mov_b32 v72, v84
v_mov_b32 v73, v85
s_mov_b32 exec_lo, 0x000f000f
s_mov_b32 exec_hi, 0x000f000f
v_bfi_b32 v70, v1, s68, v70
v_bfi_b32 v71, v1, s69, v71
v_bfi_b32 v72, v1, s70, v72
v_bfi_b32 v73, v1, s71, v73
buffer_store_dwordx4 v[70:73], v18, s[48:51], s11 offen sc1
s_mov_b64 exec, -1
L_nocrit:
v_lshlrev_b32 v20, 16, v7
v_and_b32 v21, 0xffff0000, v7
v_lshlrev_b32 v22, 16, v8
v_and_b32 v23, 0xffff0000, v8
v_lshlrev_b32 v24, 16, v9
v_and_b32 v25, 0xffff0000, v9
v_lshlrev_b32 v26, 16, v10
v_and_b32 v27, 0xffff0000, v10
v_lshlrev_b32 v28, 16, v11
v_and_b32 v29, 0xffff0000, v11
v_add_f32 v30, v20, v21
v_add_f32 v30, v30, v22
v_add_f32 v30, v30, v23
v_add_f32 v30, v30, v24
v_add_f32 v30, v30, v25
v_add_f32 v30, v30, v26
v_add_f32 v30, v30, v27
v_add_f32 v30, v30, v28
v_add_f32 v30, v30, v29
s_nop 1
v_add_f32_dpp v30, v30, v30 quad_perm:[1,0,3,2] row_mask:0xf bank_mask:0xf
s_nop 1
v_add_f32_dpp v30, v30, v30 quad_perm:[2,3,0,1] row_mask:0xf bank_mask:0xf
s_nop 1
v_add_f32_dpp v30, v30, v30 row_half_mirror row_mask:0xf bank_mask:0xf
s_nop 1
v_add_f32_dpp v30, v30, v30 row_mirror row_mask:0xf bank_mask:0xf
s_nop 1
v_add_f32_dpp v30, v30, v30 row_bcast:15 row_mask:0xa bank_mask:0xf
s_nop 1
v_add_f32_dpp v30, v30, v30 row_bcast:31 row_mask:0xc bank_mask:0xf
s_nop 0
v_readlane_b32 s11, v30, 63
v_mov_b32 v31, 0x3acccccd
s_nop 0
v_mul_f32 v31, s11, v31
v_sub_f32 v20, v20, v31
v_sub_f32 v21, v21, v31
v_sub_f32 v22, v22, v31
v_sub_f32 v23, v23, v31
v_sub_f32 v24, v24, v31
v_sub_f32 v25, v25, v31
v_sub_f32 v26, v26, v31
v_sub_f32 v27, v27, v31
v_sub_f32 v28, v28, v31
v_sub_f32 v29, v29, v31
v_mul_f32 v30, v20, v20
v_fmac_f32 v30, v21, v21
v_fmac_f32 v30, v22, v22
v_fmac_f32 v30, v23, v23
v_fmac_f32 v30, v24, v24
v_fmac_f32 v30, v25, v25
v_fmac_f32 v30, v26, v26
v_fmac_f32 v30, v27, v27
v_fmac_f32 v30, v28, v28
v_fmac_f32 v30, v29, v29
s_nop 1
v_add_f32_dpp v30, v30, v30 quad_perm:[1,0,3,2] row_mask:0xf bank_mask:0xf
s_nop 1
v_add_f32_dpp v30, v30, v30 quad_perm:[2,3,0,1] row_mask:0xf bank_mask:0xf
s_nop 1
v_add_f32_dpp v30, v30, v30 row_half_mirror row_mask:0xf bank_mask:0xf
s_nop 1
v_add_f32_dpp v30, v30, v30 row_mirror row_mask:0xf bank_mask:0xf
s_nop 1
v_add_f32_dpp v30, v30, v30 row_bcast:15 row_mask:0xa bank_mask:0xf
s_nop 1
v_add_f32_dpp v30, v30, v30 row_bcast:31 row_mask:0xc bank_mask:0xf
s_nop 0
v_readlane_b32 s11, v30, 63
v_mov_b32 v32, 0x3acccccd
s_nop 0
v_mul_f32 v32, s11, v32
v_cvt_pk_bf16_f32 v33, v31, v32
v_lshlrev_b32 v31, 16, v33
v_and_b32 v32, 0xffff0000, v33
v_add_f32 v32, 0x3727c5ac, v32
v_cvt_pk_bf16_f32 v32, v32, v32
v_lshlrev_b32 v32, 16, v32
v_sqrt_f32 v32, v32
s_nop 0
v_cvt_pk_bf16_f32 v32, v32, v32
v_lshlrev_b32 v32, 16, v32
v_rcp_f32 v32, v32
v_lshlrev_b32 v34, 16, v12
v_and_b32 v35, 0xffff0000, v12
v_lshlrev_b32 v36, 16, v13
v_and_b32 v37, 0xffff0000, v13
v_sub_f32 v34, v34, v31
v_sub_f32 v35, v35, v31
v_sub_f32 v36, v36, v31
v_sub_f32 v37, v37, v31
v_cvt_pk_bf16_f32 v33, v34, v35
v_lshlrev_b32 v34, 16, v33
v_and_b32 v35, 0xffff0000, v33
v_cvt_pk_bf16_f32 v33, v36, v37
v_lshlrev_b32 v36, 16, v33
v_and_b32 v37, 0xffff0000, v33
v_mul_f32 v34, v34, v32
v_mul_f32 v35, v35, v32
v_mul_f32 v36, v36, v32
v_mul_f32 v37, v37, v32
v_cvt_pk_bf16_f32 v33, v34, v35
v_lshlrev_b32 v8, 16, v33
v_and_b32 v9, 0xffff0000, v33
v_cvt_pk_bf16_f32 v33, v36, v37
v_lshlrev_b32 v10, 16, v33
v_and_b32 v11, 0xffff0000, v33
s_mov_b32 s77, 0
v_mov_b32 v3, 163008
L_lw_24:
ds_read_b32 v2, v3
s_waitcnt lgkmcnt(0)
v_readfirstlane_b32 s11, v2
s_nop 0
s_cmp_ge_u32 s11, 3
s_cbranch_scc1 L_lwd_26
s_sleep 2
s_add_u32 s77, s77, 1
s_cmp_lt_u32 s77, 1600000
s_cbranch_scc1 L_lw_24
L_lwd_26:
s_mul_i32 s11, s7, 320
v_and_b32 v18, 31, v0
v_lshl_add_u32 v18, v18, 4, s11
v_lshrrev_b32 v19, 5, v0
v_mul_u32_u24 v19, 2560, v19
v_add_u32 v18, v18, v19
v_lshlrev_b32 v16, 3, v0
v_add_u32 v16, 162560, v16
v_mov_b32 v17, 163020
v_mov_b32 v19, 1
s_mov_b32 exec_lo, 0x000fffff
s_mov_b32 exec_hi, 0x000fffff
s_mov_b32 s75, 0
s_mov_b32 s76, 0
s_mov_b32 s77, 0
s_mov_b32 s11, 4096
buffer_load_dwordx4 v[20:23], v18, s[48:51], s11 offen sc1
s_mov_b32 s11, 9216
buffer_load_dwordx4 v[24:27], v18, s[48:51], s11 offen sc1
s_mov_b32 s11, 14336
buffer_load_dwordx4 v[28:31], v18, s[48:51], s11 offen sc1
s_mov_b32 s11, 19456
buffer_load_dwordx4 v[32:35], v18, s[48:51], s11 offen sc1
s_mov_b32 s11, 24576
buffer_load_dwordx4 v[36:39], v18, s[48:51], s11 offen sc1
s_mov_b32 s11, 29696
buffer_load_dwordx4 v[40:43], v18, s[48:51], s11 offen sc1
s_mov_b32 s11, 34816
buffer_load_dwordx4 v[44:47], v18, s[48:51], s11 offen sc1
s_mov_b32 s11, 39936
buffer_load_dwordx4 v[48:51], v18, s[48:51], s11 offen sc1
s_sleep 10
s_mov_b32 s11, 4096
buffer_load_dwordx4 v[52:55], v18, s[48:51], s11 offen sc1
s_mov_b32 s11, 9216
buffer_load_dwordx4 v[56:59], v18, s[48:51], s11 offen sc1
s_mov_b32 s11, 14336
buffer_load_dwordx4 v[60:63], v18, s[48:51], s11 offen sc1
s_mov_b32 s11, 19456
buffer_load_dwordx4 v[64:67], v18, s[48:51], s11 offen sc1
s_mov_b32 s11, 24576
buffer_load_dwordx4 v[68:71], v18, s[48:51], s11 offen sc1
s_mov_b32 s11, 29696
buffer_load_dwordx4 v[72:75], v18, s[48:51], s11 offen sc1
s_mov_b32 s11, 34816
buffer_load_dwordx4 v[76:79], v18, s[48:51], s11 offen sc1
s_mov_b32 s11, 39936
buffer_load_dwordx4 v[80:83], v18, s[48:51], s11 offen sc1
L_pp_27:
s_waitcnt vmcnt(8)
v_perm_b32 v14, v21, v20, s72
v_perm_b32 v15, v23, v22, s73
v_or_b32 v14, v14, v15
v_cmp_ne_u32 s[78:79], s9, v14
v_perm_b32 v14, v25, v24, s72
v_perm_b32 v15, v27, v26, s73
v_or_b32 v14, v14, v15
v_cmp_ne_u32 vcc, s9, v14
s_nop 0
s_or_b64 s[78:79], s[78:79], vcc
v_perm_b32 v14, v29, v28, s72
v_perm_b32 v15, v31, v30, s73
v_or_b32 v14, v14, v15
v_cmp_ne_u32 vcc, s9, v14
s_nop 0
s_or_b64 s[78:79], s[78:79], vcc
v_perm_b32 v14, v33, v32, s72
v_perm_b32 v15, v35, v34, s73
v_or_b32 v14, v14, v15
v_cmp_ne_u32 vcc, s9, v14
s_nop 0
s_or_b64 s[78:79], s[78:79], vcc
v_perm_b32 v14, v37, v36, s72
v_perm_b32 v15, v39, v38, s73
v_or_b32 v14, v14, v15
v_cmp_ne_u32 vcc, s9, v14
s_nop 0
s_or_b64 s[78:79], s[78:79], vcc
v_perm_b32 v14, v41, v40, s72
v_perm_b32 v15, v43, v42, s73
v_or_b32 v14, v14, v15
v_cmp_ne_u32 vcc, s9, v14
s_nop 0
s_or_b64 s[78:79], s[78:79], vcc
v_perm_b32 v14, v45, v44, s72
v_perm_b32 v15, v47, v46, s73
v_or_b32 v14, v14, v15
v_cmp_ne_u32 vcc, s9, v14
s_nop 0
s_or_b64 s[78:79], s[78:79], vcc
v_perm_b32 v14, v49, v48, s72
v_perm_b32 v15, v51, v50, s73
v_or_b32 v14, v14, v15
v_cmp_ne_u32 vcc, s9, v14
s_nop 0
s_or_b64 s[78:79], s[78:79], vcc
s_cmp_lg_u64 s[78:79], 0
s_cbranch_scc0 L_ppd_31
s_mov_b32 s11, 4096
buffer_load_dwordx4 v[20:23], v18, s[48:51], s11 offen sc1
s_mov_b32 s11, 9216
buffer_load_dwordx4 v[24:27], v18, s[48:51], s11 offen sc1
s_mov_b32 s11, 14336
buffer_load_dwordx4 v[28:31], v18, s[48:51], s11 offen sc1
s_mov_b32 s11, 19456
buffer_load_dwordx4 v[32:35], v18, s[48:51], s11 offen sc1
s_mov_b32 s11, 24576
buffer_load_dwordx4 v[36:39], v18, s[48:51], s11 offen sc1
s_mov_b32 s11, 29696
buffer_load_dwordx4 v[40:43], v18, s[48:51], s11 offen sc1
s_mov_b32 s11, 34816
buffer_load_dwordx4 v[44:47], v18, s[48:51], s11 offen sc1
s_mov_b32 s11, 39936
buffer_load_dwordx4 v[48:51], v18, s[48:51], s11 offen sc1
s_waitcnt vmcnt(8)
v_perm_b32 v14, v53, v52, s72
v_perm_b32 v15, v55, v54, s73
v_or_b32 v14, v14, v15
v_cmp_ne_u32 s[78:79], s9, v14
v_perm_b32 v14, v57, v56, s72
v_perm_b32 v15, v59, v58, s73
v_or_b32 v14, v14, v15
v_cmp_ne_u32 vcc, s9, v14
s_nop 0
s_or_b64 s[78:79], s[78:79], vcc
v_perm_b32 v14, v61, v60, s72
v_perm_b32 v15, v63, v62, s73
v_or_b32 v14, v14, v15
v_cmp_ne_u32 vcc, s9, v14
s_nop 0
s_or_b64 s[78:79], s[78:79], vcc
v_perm_b32 v14, v65, v64, s72
v_perm_b32 v15, v67, v66, s73
v_or_b32 v14, v14, v15
v_cmp_ne_u32 vcc, s9, v14
s_nop 0
s_or_b64 s[78:79], s[78:79], vcc
v_perm_b32 v14, v69, v68, s72
v_perm_b32 v15, v71, v70, s73
v_or_b32 v14, v14, v15
v_cmp_ne_u32 vcc, s9, v14
s_nop 0
s_or_b64 s[78:79], s[78:79], vcc
v_perm_b32 v14, v73, v72, s72
v_perm_b32 v15, v75, v74, s73
v_or_b32 v14, v14, v15
v_cmp_ne_u32 vcc, s9, v14
s_nop 0
s_or_b64 s[78:79], s[78:79], vcc
v_perm_b32 v14, v77, v76, s72
v_perm_b32 v15, v79, v78, s73
v_or_b32 v14, v14, v15
v_cmp_ne_u32 vcc, s9, v14
s_nop 0
s_or_b64 s[78:79], s[78:79], vcc
v_perm_b32 v14, v81, v80, s72
v_perm_b32 v15, v83, v82, s73
v_or_b32 v14, v14, v15
v_cmp_ne_u32 vcc, s9, v14
s_nop 0
s_or_b64 s[78:79], s[78:79], vcc
s_cmp_lg_u64 s[78:79], 0
s_cbranch_scc0 L_ppd_32
s_mov_b32 s11, 4096
buffer_load_dwordx4 v[52:55], v18, s[48:51], s11 offen sc1
s_mov_b32 s11, 9216
buffer_load_dwordx4 v[56:59], v18, s[48:51], s11 offen sc1
s_mov_b32 s11, 14336
buffer_load_dwordx4 v[60:63], v18, s[48:51], s11 offen sc1
s_mov_b32 s11, 19456
buffer_load_dwordx4 v[64:67], v18, s[48:51], s11 offen sc1
s_mov_b32 s11, 24576
buffer_load_dwordx4 v[68:71], v18, s[48:51], s11 offen sc1
s_mov_b32 s11, 29696
buffer_load_dwordx4 v[72:75], v18, s[48:51], s11 offen sc1
s_mov_b32 s11, 34816
buffer_load_dwordx4 v[76:79], v18, s[48:51], s11 offen sc1
s_mov_b32 s11, 39936
buffer_load_dwordx4 v[80:83], v18, s[48:51], s11 offen sc1
s_add_u32 s76, s76, 1
s_cmp_lt_u32 s76, 200000
s_cbranch_scc1 L_pp_27
L_ppd_31:
v_pk_add_f32 v[148:149], v[20:21], v[24:25]
v_pk_add_f32 v[152:153], v[28:29], v[32:33]
v_pk_add_f32 v[150:151], v[22:23], v[26:27]
v_pk_add_f32 v[154:155], v[30:31], v[34:35]
v_pk_add_f32 v[20:21], v[36:37], v[40:41]
v_pk_add_f32 v[24:25], v[44:45], v[48:49]
v_pk_add_f32 v[22:23], v[38:39], v[42:43]
v_pk_add_f32 v[26:27], v[46:47], v[50:51]
v_pk_add_f32 v[148:149], v[148:149], v[152:153]
v_pk_add_f32 v[20:21], v[20:21], v[24:25]
v_pk_add_f32 v[150:151], v[150:151], v[154:155]
v_pk_add_f32 v[22:23], v[22:23], v[26:27]
v_pk_add_f32 v[148:149], v[148:149], v[20:21]
v_pk_add_f32 v[150:151], v[150:151], v[22:23]
s_branch L_ppc_28
L_ppd_32:
v_pk_add_f32 v[148:149], v[52:53], v[56:57]
v_pk_add_f32 v[152:153], v[60:61], v[64:65]
v_pk_add_f32 v[150:151], v[54:55], v[58:59]
v_pk_add_f32 v[154:155], v[62:63], v[66:67]
v_pk_add_f32 v[52:53], v[68:69], v[72:73]
v_pk_add_f32 v[56:57], v[76:77], v[80:81]
v_pk_add_f32 v[54:55], v[70:71], v[74:75]
v_pk_add_f32 v[58:59], v[78:79], v[82:83]
v_pk_add_f32 v[148:149], v[148:149], v[152:153]
v_pk_add_f32 v[52:53], v[52:53], v[56:57]
v_pk_add_f32 v[150:151], v[150:151], v[154:155]
v_pk_add_f32 v[54:55], v[54:55], v[58:59]
v_pk_add_f32 v[148:149], v[148:149], v[52:53]
v_pk_add_f32 v[150:151], v[150:151], v[54:55]
L_ppc_28:
s_mov_b64 exec, -1
v_cvt_pk_bf16_f32 v14, v148, v149
v_lshlrev_b32 v148, 16, v14
v_and_b32 v149, 0xffff0000, v14
v_cvt_pk_bf16_f32 v15, v150, v151
v_lshlrev_b32 v150, 16, v15
v_and_b32 v151, 0xffff0000, v15
v_add_f32 v152, 1.0, v148
v_add_f32 v153, 1.0, v149
v_add_f32 v154, 1.0, v150
v_add_f32 v155, 1.0, v151
v_cvt_pk_bf16_f32 v14, v152, v153
v_lshlrev_b32 v152, 16, v14
v_and_b32 v153, 0xffff0000, v14
v_cvt_pk_bf16_f32 v15, v154, v155
v_lshlrev_b32 v154, 16, v15
v_and_b32 v155, 0xffff0000, v15
v_mov_b32 v84, v152
v_mov_b32 v85, v153
v_mov_b32 v86, v154
v_mov_b32 v87, v155
v_permlane32_swap_b32 v152, v84
v_permlane32_swap_b32 v153, v85
v_permlane32_swap_b32 v154, v86
v_permlane32_swap_b32 v155, v87
v_mul_f32 v84, v8, v84
v_mul_f32 v85, v9, v85
v_mul_f32 v86, v10, v86
v_mul_f32 v87, v11, v87
v_cvt_pk_bf16_f32 v14, v84, v85
v_lshlrev_b32 v84, 16, v14
v_and_b32 v85, 0xffff0000, v14
v_cvt_pk_bf16_f32 v15, v86, v87
v_lshlrev_b32 v86, 16, v15
v_and_b32 v87, 0xffff0000, v15
v_add_f32 v84, v84, v148
v_add_f32 v85, v85, v149
v_add_f32 v86, v86, v150
v_add_f32 v87, v87, v151
v_cvt_pk_bf16_f32 v84, v84, v85
v_cvt_pk_bf16_f32 v85, v86, v87
s_mov_b32 exec_lo, 0x000fffff
s_mov_b32 exec_hi, 0x00000000
ds_write_b64 v16, v[84:85]
s_mov_b32 exec_lo, 0x00000001
s_mov_b32 exec_hi, 0x00000000
ds_write_b32 v17, v19
s_mov_b64 exec, -1
s_lshl_b32 s12, s4, 14
s_lshl_b32 s13, s6, 12
s_add_u32 s12, s12, s13
s_add_u32 s12, s12, 172032
v_and_b32 v18, 31, v0
v_lshlrev_b32 v18, 4, v18
v_lshrrev_b32 v19, 5, v0
v_lshl_add_u32 v18, v19, 11, v18
v_add_u32 v12, s12, v18
s_waitcnt vmcnt(0)
s_mov_b32 s77, 0
v_mov_b32 v3, 163032
L_lw_33:
ds_read_b32 v2, v3
s_waitcnt lgkmcnt(0)
v_readfirstlane_b32 s11, v2
s_nop 0
s_cmp_ge_u32 s11, 8
s_cbranch_scc1 L_lwd_35
s_add_u32 s77, s77, 1
s_cmp_lt_u32 s77, 1600000
s_cbranch_scc1 L_lw_33
L_lwd_35:
s_mov_b32 s75, 0
s_mov_b32 s76, 0
s_mov_b32 s77, 0
buffer_load_dwordx4 v[20:23], v12, s[48:51], s75 offen offset:0 sc1
buffer_load_dwordx4 v[24:27], v12, s[48:51], s75 offen offset:512 sc1
buffer_load_dwordx4 v[28:31], v12, s[48:51], s75 offen offset:1024 sc1
buffer_load_dwordx4 v[32:35], v12, s[48:51], s75 offen offset:1536 sc1
s_sleep 8
buffer_load_dwordx4 v[36:39], v12, s[48:51], s75 offen offset:0 sc1
buffer_load_dwordx4 v[40:43], v12, s[48:51], s75 offen offset:512 sc1
buffer_load_dwordx4 v[44:47], v12, s[48:51], s75 offen offset:1024 sc1
buffer_load_dwordx4 v[48:51], v12, s[48:51], s75 offen offset:1536 sc1
L_pp_36:
s_waitcnt vmcnt(4)
v_perm_b32 v14, v21, v20, s72
v_perm_b32 v15, v23, v22, s73
v_or_b32 v14, v14, v15
v_cmp_ne_u32 s[78:79], s9, v14
v_perm_b32 v14, v25, v24, s72
v_perm_b32 v15, v27, v26, s73
v_or_b32 v14, v14, v15
v_cmp_ne_u32 vcc, s9, v14
s_nop 0
s_or_b64 s[78:79], s[78:79], vcc
v_perm_b32 v14, v29, v28, s72
v_perm_b32 v15, v31, v30, s73
v_or_b32 v14, v14, v15
v_cmp_ne_u32 vcc, s9, v14
s_nop 0
s_or_b64 s[78:79], s[78:79], vcc
v_perm_b32 v14, v33, v32, s72
v_perm_b32 v15, v35, v34, s73
v_or_b32 v14, v14, v15
v_cmp_ne_u32 vcc, s9, v14
s_nop 0
s_or_b64 s[78:79], s[78:79], vcc
s_cmp_lg_u64 s[78:79], 0
s_cbranch_scc0 L_ppd_40
buffer_load_dwordx4 v[20:23], v12, s[48:51], s75 offen offset:0 sc1
buffer_load_dwordx4 v[24:27], v12, s[48:51], s75 offen offset:512 sc1
buffer_load_dwordx4 v[28:31], v12, s[48:51], s75 offen offset:1024 sc1
buffer_load_dwordx4 v[32:35], v12, s[48:51], s75 offen offset:1536 sc1
s_waitcnt vmcnt(4)
v_perm_b32 v14, v37, v36, s72
v_perm_b32 v15, v39, v38, s73
v_or_b32 v14, v14, v15
v_cmp_ne_u32 s[78:79], s9, v14
v_perm_b32 v14, v41, v40, s72
v_perm_b32 v15, v43, v42, s73
v_or_b32 v14, v14, v15
v_cmp_ne_u32 vcc, s9, v14
s_nop 0
s_or_b64 s[78:79], s[78:79], vcc
v_perm_b32 v14, v45, v44, s72
v_perm_b32 v15, v47, v46, s73
v_or_b32 v14, v14, v15
v_cmp_ne_u32 vcc, s9, v14
s_nop 0
s_or_b64 s[78:79], s[78:79], vcc
v_perm_b32 v14, v49, v48, s72
v_perm_b32 v15, v51, v50, s73
v_or_b32 v14, v14, v15
v_cmp_ne_u32 vcc, s9, v14
s_nop 0
s_or_b64 s[78:79], s[78:79], vcc
s_cmp_lg_u64 s[78:79], 0
s_cbranch_scc0 L_ppd_41
buffer_load_dwordx4 v[36:39], v12, s[48:51], s75 offen offset:0 sc1
buffer_load_dwordx4 v[40:43], v12, s[48:51], s75 offen offset:512 sc1
buffer_load_dwordx4 v[44:47], v12, s[48:51], s75 offen offset:1024 sc1
buffer_load_dwordx4 v[48:51], v12, s[48:51], s75 offen offset:1536 sc1
s_add_u32 s76, s76, 1
s_xor_b32 s75, s75, s77
s_cmp_eq_u32 s76, 48
s_cbranch_scc1 L_ppx_38
L_ppb_39:
s_cmp_lt_u32 s76, 200000
s_cbranch_scc1 L_pp_36
L_ppd_40:
v_pk_add_f32 v[2:3], v[20:21], v[24:25]
v_pk_add_f32 v[4:5], v[22:23], v[26:27]
v_pk_add_f32 v[2:3], v[2:3], v[28:29]
v_pk_add_f32 v[4:5], v[4:5], v[30:31]
v_pk_add_f32 v[2:3], v[2:3], v[32:33]
v_pk_add_f32 v[4:5], v[4:5], v[34:35]
s_branch L_ppc_37
L_ppd_41:
v_pk_add_f32 v[2:3], v[36:37], v[40:41]
v_pk_add_f32 v[4:5], v[38:39], v[42:43]
v_pk_add_f32 v[2:3], v[2:3], v[44:45]
v_pk_add_f32 v[4:5], v[4:5], v[46:47]
v_pk_add_f32 v[2:3], v[2:3], v[48:49]
v_pk_add_f32 v[4:5], v[4:5], v[50:51]
L_ppc_37:
v_mov_b32 v6, v2
v_mov_b32 v7, v3
v_mov_b32 v8, v4
v_mov_b32 v9, v5
v_permlane32_swap_b32 v2, v6
v_permlane32_swap_b32 v3, v7
v_permlane32_swap_b32 v4, v8
v_permlane32_swap_b32 v5, v9
v_add_f32 v2, v2, v6
v_add_f32 v3, v3, v7
v_add_f32 v4, v4, v8
v_add_f32 v5, v5, v9
v_cvt_pk_bf16_f32 v2, v2, v3
v_cvt_pk_bf16_f32 v3, v4, v5
v_and_b32 v14, 31, v0
v_lshlrev_b32 v14, 3, v14
v_add_u32 v14, 162752, v14
s_mov_b32 exec_lo, 0xffffffff
s_mov_b32 exec_hi, 0x00000000
ds_write_b64 v14, v[2:3]
s_mov_b32 exec_lo, 0x00000001
s_mov_b32 exec_hi, 0x00000000
v_mov_b32 v14, 163012
v_mov_b32 v15, 1
ds_write_b32 v14, v15
s_mov_b64 exec, -1
s_endpgm
L_kv:
s_setprio 0
v_xor_b32 v4, v156, v157
v_lshlrev_b32 v4, 4, v4
v_lshl_add_u32 v4, v157, 8, v4
s_lshl_b32 s11, s8, 13
v_add_u32 v4, s11, v4
s_mov_b32 s77, 0
v_mov_b32 v3, 163008
L_lw_42:
ds_read_b32 v2, v3
s_waitcnt lgkmcnt(0)
v_readfirstlane_b32 s11, v2
s_nop 0
s_cmp_ge_u32 s11, 4
s_cbranch_scc1 L_lwd_44
s_sleep 1
s_add_u32 s77, s77, 1
s_cmp_lt_u32 s77, 1600000
s_cbranch_scc1 L_lw_42
L_lwd_44:
ds_read_b128 v[20:23], v4 offset:0
ds_read_b128 v[36:39], v4 offset:4096
v_xor_b32 v5, 64, v4
ds_read_b128 v[24:27], v5 offset:0
ds_read_b128 v[40:43], v5 offset:4096
v_xor_b32 v5, 128, v4
ds_read_b128 v[28:31], v5 offset:0
ds_read_b128 v[44:47], v5 offset:4096
v_xor_b32 v5, 192, v4
ds_read_b128 v[32:35], v5 offset:0
ds_read_b128 v[48:51], v5 offset:4096
s_waitcnt lgkmcnt(0)
s_mov_b32 exec_lo, 0x00000001
s_mov_b32 exec_hi, 0x00000000
v_mov_b32 v2, 163016
v_mov_b32 v3, 1
ds_add_u32 v2, v3
s_mov_b64 exec, -1
v_lshlrev_b32 v4, 1, v158
v_and_b32 v5, 1, v156
v_lshl_add_u32 v4, v5, 3, v4
v_lshrrev_b32 v5, 1, v159
v_xor_b32 v4, v4, v5
s_lshl_b32 s11, s8, 1
v_xor_b32 v4, s11, v4
v_lshlrev_b32 v4, 4, v4
v_and_b32 v5, 1, v159
v_lshl_add_u32 v4, v5, 3, v4
v_lshl_add_u32 v5, v156, 3, v158
v_lshl_add_u32 v4, v5, 8, v4
v_add_u32 v93, 65536, v4
s_lshl_b32 s12, s4, 14
s_lshl_b32 s13, s6, 12
s_add_u32 s12, s12, s13
s_lshl_b32 s13, s7, 4
s_add_u32 s12, s12, s13
s_lshl_b32 s13, s8, 9
s_add_u32 s12, s12, s13
s_add_u32 s12, s12, 303104
v_lshlrev_b32 v92, 7, v156
v_add_u32 v92, s12, v92
s_lshr_b32 s13, s8, 1
s_lshl_b32 s11, s4, 9
s_lshl_b32 s12, s13, 7
s_add_u32 s11, s11, s12
s_add_u32 s11, s11, 131072
v_and_b32 v2, 7, v0
v_lshl_add_u32 v94, v2, 4, s11
s_lshl_b32 s11, s4, 14
s_lshl_b32 s12, s13, 12
s_add_u32 s11, s11, s12
s_and_b32 s12, s8, 1
s_lshl_b32 s12, s12, 11
s_add_u32 s11, s11, s12
s_add_u32 s11, s11, 303104
v_lshrrev_b32 v5, 3, v0
v_lshlrev_b32 v3, 4, v5
v_lshl_add_u32 v95, v0, 4, s11
s_lshl_b32 s11, s8, 7
s_add_u32 s12, s11, 131584
v_lshl_add_u32 v98, v5, 3, s12
v_lshl_add_u32 v99, v156, 4, s12
s_add_u32 s12, s11, 133120
v_lshl_add_u32 v130, v156, 4, s12
v_lshl_add_u32 v131, v2, 7, v3
v_add_u32 v131, 133120, v131
v_mul_u32_u24 v132, 20480, v2
v_add_u32 v132, v132, v3
v_and_b32 v6, 1, v156
v_lshlrev_b32 v6, 1, v6
v_lshrrev_b32 v7, 1, v159
v_xor_b32 v6, v6, v7
v_lshlrev_b32 v6, 4, v6
v_and_b32 v7, 1, v159
v_lshl_add_u32 v6, v7, 3, v6
v_lshl_add_u32 v7, v156, 3, v158
v_lshl_add_u32 v6, v7, 6, v6
s_lshl_b32 s11, s8, 12
v_add_u32 v96, s11, v6
v_xor_b32 v97, 32, v96
s_mul_i32 s82, s4, 2560
s_lshl_b32 s12, s5, 7
s_add_u32 s82, s82, s12
s_add_u32 s82, s82, 1048576
s_mul_i32 s11, s4, 20480
s_lshl_b32 s12, s5, 7
s_add_u32 s11, s11, s12
s_add_u32 s13, s11, 1048576
v_mul_u32_u24 v137, 2560, v2
v_add_u32 v137, v137, v3
v_add_u32 v137, s13, v137
s_add_u32 s13, s11, 1245184
v_and_b32 v4, 1, v2
v_mul_u32_u24 v4, 10240, v4
v_lshrrev_b32 v6, 1, v2
v_mul_u32_u24 v6, 2560, v6
v_add3_u32 v138, v4, v6, v3
v_add_u32 v138, s13, v138
s_mul_i32 s11, s4, 10240
s_add_u32 s11, s11, s12
s_add_u32 s11, s11, 434176
v_add_u32 v139, v6, v3
v_add_u32 v139, s11, v139
s_mov_b32 s52, s16
s_mov_b32 s53, s17
s_mov_b32 s54, 1280
s_mov_b32 s55, 0x20000
s_lshl_b32 s11, s5, 6
v_lshl_add_u32 v4, v5, 3, s11
s_cmp_lg_u32 s8, 0
s_cbranch_scc1 L_x0_45
buffer_load_dwordx2 v[140:141], v4, s[52:55], 0 offen
L_x0_45:
s_mul_i32 s12, s5, 3
s_sub_u32 s13, s5, 16
s_lshl_b32 s13, s13, 1
s_add_u32 s13, s13, 48
s_cmp_lt_u32 s5, 16
s_cselect_b32 s12, s12, s13
s_cselect_b32 s74, 7, 3
s_mul_i32 s11, s4, 80
s_add_u32 s11, s11, s12
s_lshl_b32 s11, s11, 1
v_lshl_add_u32 v136, v0, 1, s11
v_add_u32 v147, 135680, v136
s_lshl_b32 s11, s8, 6
v_add_u32 v4, s11, v0
v_subrev_u32 v6, 32, v4
v_mov_b32 v7, 160
v_cmp_lt_u32 s[80:81], v4, v7
s_nop 1
v_cndmask_b32 v4, v6, v4, s[80:81]
v_lshlrev_b32 v6, 4, v4
s_mul_i32 s12, s4, 10240
s_add_u32 s12, s12, 434176
v_add_u32 v133, s12, v6
v_add_u32 v148, 5120, v133
v_lshlrev_b32 v146, 3, v4
v_add_u32 v146, 135680, v146
v_and_b32 v155, 31, v0
v_lshlrev_b32 v155, 4, v155
s_lshl_b32 s11, s4, 9
s_add_u32 s11, s11, 131072
v_add_u32 v155, s11, v155
s_lshl_b32 s11, s8, 3
s_add_u32 s11, s11, 135168
v_mov_b32 v144, s11
v_mov_b32 v145, 135168
s_lshl_b32 s11, s8, 2
s_add_u32 s11, s11, 135424
v_mov_b32 v134, s11
v_lshlrev_b32 v135, 5, v0
v_add_u32 v135, 135424, v135
s_mov_b32 s91, 0xbdd2d3e8
v_mov_b32 v129, 0xc0135761
s_mov_b32 s83, 0x07060302
s_mov_b32 s56, s40
s_mov_b32 s57, s41
s_mov_b32 s58, 1280
s_mov_b32 s59, 0x20000
s_mov_b64 s[94:95], 0
s_mov_b32 s77, 0
s_mov_b32 s47, 0
v_mov_b32 v4, 163008
L_qw_46:
ds_read2_b32 v[2:3], v4 offset0:1 offset1:7
s_waitcnt lgkmcnt(0)
v_readfirstlane_b32 s11, v2
v_readfirstlane_b32 s12, v3
s_nop 0
s_cmp_gt_u32 s12, s47
s_cbranch_scc1 L_qwb_48
L_qwr_49:
s_cmp_lg_u32 s11, 0
s_cbranch_scc1 L_qwd_47
s_add_u32 s77, s77, 1
s_cmp_lt_u32 s77, 1600000
s_cbranch_scc1 L_qw_46
L_qwd_47:
v_lshlrev_b32 v4, 4, v156
v_add_u32 v4, 162752, v4
ds_read_b128 v[52:55], v4 offset:0
ds_read_b128 v[56:59], v4 offset:64
ds_read_b128 v[60:63], v4 offset:128
ds_read_b128 v[64:67], v4 offset:192
s_lshl_b32 s11, s8, 2
s_add_u32 s12, s11, 163072
v_mov_b32 v2, s12
v_mov_b32 v3, 163024
v_mov_b32 v5, 1
s_waitcnt lgkmcnt(3)
v_mfma_f32_16x16x32_bf16 v[68:71], v[20:23], v[52:55], 0
v_mfma_f32_16x16x32_bf16 v[72:75], v[36:39], v[52:55], 0
s_waitcnt lgkmcnt(2)
v_mfma_f32_16x16x32_bf16 v[68:71], v[24:27], v[56:59], v[68:71]
v_mfma_f32_16x16x32_bf16 v[72:75], v[40:43], v[56:59], v[72:75]
s_waitcnt lgkmcnt(1)
v_mfma_f32_16x16x32_bf16 v[68:71], v[28:31], v[60:63], v[68:71]
v_mfma_f32_16x16x32_bf16 v[72:75], v[44:47], v[60:63], v[72:75]
s_waitcnt lgkmcnt(0)
v_mfma_f32_16x16x32_bf16 v[68:71], v[32:35], v[64:67], v[68:71]
v_mfma_f32_16x16x32_bf16 v[72:75], v[48:51], v[64:67], v[72:75]
s_mov_b32 s60, 0xaaaaaaaa
s_mov_b32 s61, 0xaaaaaaaa
s_mov_b32 s62, 0xcccccccc
s_mov_b32 s63, 0xcccccccc
s_mov_b32 s64, 0xf0f0f0f0
s_mov_b32 s65, 0xf0f0f0f0
v_bfe_u32 v6, v157, 2, 1
v_lshlrev_b32 v6, 4, v6
v_lshl_add_u32 v6, v156, 2, v6
v_add_u32 v6, v6, v159
v_lshlrev_b32 v6, 1, v6
s_lshl_b32 s11, s8, 6
s_add_u32 s11, s11, 131072
v_add_u32 v6, s11, v6
v_cndmask_b32 v76, v68, v69, s[60:61]
v_cndmask_b32 v77, v70, v71, s[60:61]
v_cndmask_b32 v78, v72, v73, s[60:61]
v_cndmask_b32 v79, v74, v75, s[60:61]
v_cndmask_b32 v76, v76, v77, s[62:63]
v_cndmask_b32 v78, v78, v79, s[62:63]
v_cndmask_b32 v68, v76, v78, s[64:65]
v_cvt_pk_bf16_f32 v68, v68, v68
v_lshlrev_b32 v68, 16, v68
v_mul_f32 v68, 0x3db504f3, v68
v_cvt_pk_bf16_f32 v68, v68, v68
v_lshlrev_b32 v68, 16, v68
v_mov_b32 v76, v68
s_nop 1
v_max_f32_dpp v76, v76, v76 quad_perm:[1,0,3,2] row_mask:0xf bank_mask:0xf
s_nop 1
v_max_f32_dpp v76, v76, v76 quad_perm:[2,3,0,1] row_mask:0xf bank_mask:0xf
s_nop 1
v_max_f32_dpp v76, v76, v76 row_half_mirror row_mask:0xf bank_mask:0xf
s_nop 1
v_max_f32_dpp v76, v76, v76 row_bcast:15 row_mask:0xa bank_mask:0xf
s_nop 1
v_max_f32_dpp v76, v76, v76 row_bcast:31 row_mask:0xc bank_mask:0xf
s_mov_b32 exec_lo, 0x00000000
s_mov_b32 exec_hi, 0x80000000
ds_write_b32 v2, v76
ds_add_u32 v3, v5
s_mov_b64 exec, -1
s_mov_b32 s77, 0
v_mov_b32 v3, 163024
L_lw_50:
ds_read_b32 v2, v3
s_waitcnt lgkmcnt(0)
v_readfirstlane_b32 s11, v2
s_nop 0
s_cmp_ge_u32 s11, 8
s_cbranch_scc1 L_lwd_52
s_add_u32 s77, s77, 1
s_cmp_lt_u32 s77, 1600000
s_cbranch_scc1 L_lw_50
L_lwd_52:
v_mov_b32 v2, 163072
ds_read_b128 v[76:79], v2
ds_read_b128 v[80:83], v2 offset:16
s_lshl_b32 s11, s8, 2
s_add_u32 s12, s11, 163104
v_mov_b32 v2, s12
v_mov_b32 v3, 163028
s_waitcnt lgkmcnt(0)
v_max3_f32 v76, v76, v77, v78
v_max3_f32 v79, v79, v80, v81
v_max3_f32 v76, v76, v82, v83
v_max_f32 v90, v76, v79
v_sub_f32 v68, v68, v90
v_mul_f32 v68, 0x3fb8aa3b, v68
v_exp_f32 v68, v68
s_nop 0
v_mov_b32 v76, v68
v_cvt_pk_bf16_f32 v69, v68, v68
s_mov_b32 exec_lo, 0x00ff00ff
s_mov_b32 exec_hi, 0x00ff00ff
ds_write_b16 v6, v69
s_mov_b64 exec, -1
s_nop 0
v_add_f32_dpp v76, v76, v76 quad_perm:[1,0,3,2] row_mask:0xf bank_mask:0xf
s_nop 1
v_add_f32_dpp v76, v76, v76 quad_perm:[2,3,0,1] row_mask:0xf bank_mask:0xf
s_nop 1
v_add_f32_dpp v76, v76, v76 row_half_mirror row_mask:0xf bank_mask:0xf
s_nop 1
v_add_f32_dpp v76, v76, v76 row_bcast:15 row_mask:0xa bank_mask:0xf
s_nop 1
v_add_f32_dpp v76, v76, v76 row_bcast:31 row_mask:0xc bank_mask:0xf
s_mov_b32 exec_lo, 0x00000000
s_mov_b32 exec_hi, 0x80000000
ds_write_b32 v2, v76
ds_add_u32 v3, v5
s_mov_b64 exec, -1
s_mov_b32 s77, 0
v_mov_b32 v3, 163028
L_lw_53:
ds_read_b32 v2, v3
s_waitcnt lgkmcnt(0)
v_readfirstlane_b32 s11, v2
s_nop 0
s_cmp_ge_u32 s11, 8
s_cbranch_scc1 L_lwd_55
s_add_u32 s77, s77, 1
s_cmp_lt_u32 s77, 1600000
s_cbranch_scc1 L_lw_53
L_lwd_55:
v_lshlrev_b32 v4, 4, v156
v_add_u32 v4, 131072, v4
ds_read_b128 v[20:23], v4 offset:0
ds_read_b128 v[24:27], v4 offset:64
ds_read_b128 v[28:31], v4 offset:128
ds_read_b128 v[32:35], v4 offset:192
ds_read_b128 v[36:39], v4 offset:256
ds_read_b128 v[40:43], v4 offset:320
ds_read_b128 v[44:47], v4 offset:384
ds_read_b128 v[48:51], v4 offset:448
v_mov_b32 v2, 163104
ds_read_b128 v[76:79], v2
ds_read_b128 v[80:83], v2 offset:16
s_waitcnt lgkmcnt(0)
v_add_f32 v76, v76, v77
v_add_f32 v78, v78, v79
v_add_f32 v80, v80, v81
v_add_f32 v82, v82, v83
v_add_f32 v76, v76, v78
v_add_f32 v80, v80, v82
v_add_f32 v91, v76, v80
s_getreg_b32 s46, hwreg(HW_REG_XCC_ID, 0, 4)
s_lshl_b32 s46, s46, 8
s_or_b32 s46, s46, 0x1000
s_mov_b32 s90, s46
v_mov_b32 v150, v90
v_mov_b32 v151, v91
v_mov_b32 v152, s46
v_mov_b32 v153, 0
v_bfi_b32 v150, v1, s68, v150
v_bfi_b32 v151, v1, s69, v151
v_bfi_b32 v152, v1, s70, v152
v_bfi_b32 v153, v1, s71, v153
s_lshl_b32 s11, s4, 9
s_lshl_b32 s12, s6, 7
s_add_u32 s11, s11, s12
s_lshl_b32 s12, s7, 4
s_add_u32 s11, s11, s12
s_add_u32 s11, s11, 131072
v_mov_b32 v154, s11
s_cmp_lg_u32 s8, 0
s_cbranch_scc1 L_noml
s_mov_b32 exec_lo, 0x00000001
s_mov_b32 exec_hi, 0x00000000
buffer_store_dwordx4 v[150:153], v154, s[48:51], 0 offen
s_mov_b64 exec, -1
L_noml:
s_mov_b32 s77, 0
v_mov_b32 v3, 163008
L_lw_56:
ds_read_b32 v2, v3
s_waitcnt lgkmcnt(0)
v_readfirstlane_b32 s11, v2
s_nop 0
s_cmp_ge_u32 s11, 6
s_cbranch_scc1 L_lwd_58
s_add_u32 s77, s77, 1
s_cmp_lt_u32 s77, 1600000
s_cbranch_scc1 L_lw_56
L_lwd_58:
ds_read_b64_tr_b16 v[52:53], v93 offset:0
ds_read_b64_tr_b16 v[54:55], v93 offset:1024
ds_read_b64_tr_b16 v[56:57], v93 offset:8192
ds_read_b64_tr_b16 v[58:59], v93 offset:9216
ds_read_b64_tr_b16 v[60:61], v93 offset:16384
ds_read_b64_tr_b16 v[62:63], v93 offset:17408
ds_read_b64_tr_b16 v[64:65], v93 offset:24576
ds_read_b64_tr_b16 v[66:67], v93 offset:25600
ds_read_b64_tr_b16 v[68:69], v93 offset:32768
ds_read_b64_tr_b16 v[70:71], v93 offset:33792
ds_read_b64_tr_b16 v[72:73], v93 offset:40960
ds_read_b64_tr_b16 v[74:75], v93 offset:41984
ds_read_b64_tr_b16 v[76:77], v93 offset:49152
ds_read_b64_tr_b16 v[78:79], v93 offset:50176
ds_read_b64_tr_b16 v[80:81], v93 offset:57344
ds_read_b64_tr_b16 v[82:83], v93 offset:58368
s_waitcnt lgkmcnt(14)
v_mfma_f32_16x16x32_bf16 v[84:87], v[52:55], v[20:23], 0
s_waitcnt lgkmcnt(12)
v_mfma_f32_16x16x32_bf16 v[84:87], v[56:59], v[24:27], v[84:87]
s_waitcnt lgkmcnt(10)
v_mfma_f32_16x16x32_bf16 v[84:87], v[60:63], v[28:31], v[84:87]
s_waitcnt lgkmcnt(8)
v_mfma_f32_16x16x32_bf16 v[84:87], v[64:67], v[32:35], v[84:87]
s_waitcnt lgkmcnt(6)
v_mfma_f32_16x16x32_bf16 v[84:87], v[68:71], v[36:39], v[84:87]
s_waitcnt lgkmcnt(4)
v_mfma_f32_16x16x32_bf16 v[84:87], v[72:75], v[40:43], v[84:87]
s_waitcnt lgkmcnt(2)
v_mfma_f32_16x16x32_bf16 v[84:87], v[76:79], v[44:47], v[84:87]
s_waitcnt lgkmcnt(0)
v_mfma_f32_16x16x32_bf16 v[84:87], v[80:83], v[48:51], v[84:87]
s_mov_b32 exec_lo, 0x00010001
s_mov_b32 exec_hi, 0x00010001
s_nop 5
v_bfi_b32 v84, v1, s68, v84
v_bfi_b32 v85, v1, s69, v85
v_bfi_b32 v86, v1, s70, v86
v_bfi_b32 v87, v1, s71, v87
buffer_store_dwordx4 v[84:87], v92, s[48:51], 0 offen
s_mov_b64 exec, -1
s_cmp_ge_u32 s5, 20
s_cbranch_scc1 L_notW
s_mov_b32 s75, 0
buffer_load_dwordx4 v[20:23], v94, s[48:51], s75 offen sc1
buffer_load_dwordx4 v[36:39], v155, s[48:51], s75 offen sc1
buffer_load_dwordx4 v[24:27], v95, s[48:51], s75 offen sc1
buffer_load_dwordx4 v[28:31], v95, s[48:51], s75 offen offset:1024 sc1
s_waitcnt vmcnt(2)
v_perm_b32 v14, v21, v20, s72
v_perm_b32 v15, v23, v22, s73
v_or_b32 v14, v14, v15
v_cmp_ne_u32 s[78:79], s9, v14
v_perm_b32 v14, v37, v36, s72
v_perm_b32 v15, v39, v38, s73
v_or_b32 v14, v14, v15
v_cmp_ne_u32 vcc, s9, v14
s_nop 0
s_or_b64 s[78:79], s[78:79], vcc
s_cmp_lg_u64 s[78:79], 0
s_cbranch_scc0 L_mlok_60
s_mov_b32 s75, 0
s_mov_b32 s76, 0
s_mov_b32 s77, 0
s_mov_b64 s[98:99], exec
L_poll_62:
buffer_load_dwordx4 v[20:23], v94, s[48:51], s75 offen sc1
buffer_load_dwordx4 v[36:39], v155, s[48:51], s75 offen sc1
s_waitcnt vmcnt(0)
v_perm_b32 v14, v21, v20, s72
v_perm_b32 v15, v23, v22, s73
v_or_b32 v14, v14, v15
v_cmp_ne_u32 s[78:79], s9, v14
v_perm_b32 v14, v37, v36, s72
v_perm_b32 v15, v39, v38, s73
v_or_b32 v14, v14, v15
v_cmp_ne_u32 vcc, s9, v14
s_nop 0
s_or_b64 s[78:79], s[78:79], vcc
s_cmp_lg_u64 s[78:79], 0
s_cbranch_scc0 L_pdone_63
s_mov_b64 exec, s[78:79]
s_xor_b32 s75, s75, s77
s_add_u32 s76, s76, 1
s_cmp_eq_u32 s76, 96
s_cbranch_scc1 L_pswitch_64
s_cmp_lt_u32 s76, 200000
s_cbranch_scc1 L_poll_62
L_pdone_63:
s_mov_b64 exec, s[98:99]
L_mlok_60:
v_and_b32 v38, 0xffffff00, v38
v_cmp_ne_u32 s[78:79], s90, v38
s_nop 0
s_cmp_lg_u64 s[78:79], 0
s_cbranch_scc1 L_fo_67
L_fog_68:
s_mov_b32 s46, 0
v_mov_b32 v3, 163008
ds_read_b32 v2, v3
v_and_b32 v20, 0xffff0000, v20
v_mov_b32 v32, v20
s_nop 1
v_max_f32_dpp v32, v32, v32 quad_perm:[1,0,3,2] row_mask:0xf bank_mask:0xf
s_nop 1
v_max_f32_dpp v32, v32, v32 quad_perm:[2,3,0,1] row_mask:0xf bank_mask:0xf
s_nop 1
v_max_f32_dpp v32, v32, v32 row_half_mirror row_mask:0xf bank_mask:0xf
v_sub_f32 v32, v20, v32
v_mul_f32 v32, 0x3fb8aa3b, v32
v_exp_f32 v32, v32
s_nop 0
v_mul_f32 v33, v32, v21
s_nop 1
v_add_f32_dpp v33, v33, v33 quad_perm:[1,0,3,2] row_mask:0xf bank_mask:0xf
s_nop 1
v_add_f32_dpp v33, v33, v33 quad_perm:[2,3,0,1] row_mask:0xf bank_mask:0xf
s_nop 1
v_add_f32_dpp v33, v33, v33 row_half_mirror row_mask:0xf bank_mask:0xf
v_rcp_f32 v33, v33
s_nop 0
v_mul_f32 v32, v32, v33
s_waitcnt lgkmcnt(0)
v_readfirstlane_b32 s11, v2
s_nop 0
s_cmp_lt_u32 s11, 7
s_cbranch_scc1 L_wo_71
s_mov_b32 s46, 1
ds_read_b64_tr_b16 v[52:53], v96 offset:0
ds_read_b64_tr_b16 v[54:55], v96 offset:256
ds_read_b64_tr_b16 v[60:61], v97 offset:0
ds_read_b64_tr_b16 v[62:63], v97 offset:256
ds_read_b64_tr_b16 v[56:57], v96 offset:2048
ds_read_b64_tr_b16 v[58:59], v96 offset:2304
ds_read_b64_tr_b16 v[64:65], v97 offset:2048
ds_read_b64_tr_b16 v[66:67], v97 offset:2304
L_wo_71:
s_waitcnt vmcnt(0)
v_perm_b32 v14, v25, v24, s72
v_perm_b32 v15, v27, v26, s73
v_or_b32 v14, v14, v15
v_cmp_ne_u32 s[78:79], s9, v14
v_perm_b32 v14, v29, v28, s72
v_perm_b32 v15, v31, v30, s73
v_or_b32 v14, v14, v15
v_cmp_ne_u32 vcc, s9, v14
s_nop 0
s_or_b64 s[78:79], s[78:79], vcc
s_cmp_lg_u64 s[78:79], 0
s_cbranch_scc0 L_o1_61
s_mov_b32 s75, 0
s_mov_b32 s76, 0
s_mov_b32 s77, 0
s_mov_b64 s[98:99], exec
L_poll_72:
buffer_load_dwordx4 v[24:27], v95, s[48:51], s75 offen sc1
buffer_load_dwordx4 v[28:31], v95, s[48:51], s75 offen offset:1024 sc1
s_waitcnt vmcnt(0)
v_perm_b32 v14, v25, v24, s72
v_perm_b32 v15, v27, v26, s73
v_or_b32 v14, v14, v15
v_cmp_ne_u32 s[78:79], s9, v14
v_perm_b32 v14, v29, v28, s72
v_perm_b32 v15, v31, v30, s73
v_or_b32 v14, v14, v15
v_cmp_ne_u32 vcc, s9, v14
s_nop 0
s_or_b64 s[78:79], s[78:79], vcc
s_cmp_lg_u64 s[78:79], 0
s_cbranch_scc0 L_pdone_73
s_mov_b64 exec, s[78:79]
s_xor_b32 s75, s75, s77
s_add_u32 s76, s76, 1
s_cmp_eq_u32 s76, 96
s_cbranch_scc1 L_pswitch_74
s_cmp_lt_u32 s76, 200000
s_cbranch_scc1 L_poll_72
L_pdone_73:
s_mov_b64 exec, s[98:99]
L_o1_61:
v_mul_f32 v24, v24, v32
v_mul_f32 v25, v25, v32
v_mul_f32 v26, v26, v32
v_mul_f32 v27, v27, v32
v_mul_f32 v28, v28, v32
v_mul_f32 v29, v29, v32
v_mul_f32 v30, v30, v32
v_mul_f32 v31, v31, v32
v_add_f32_dpp v24, v24, v24 quad_perm:[1,0,3,2] row_mask:0xf bank_mask:0xf
v_add_f32_dpp v25, v25, v25 quad_perm:[1,0,3,2] row_mask:0xf bank_mask:0xf
v_add_f32_dpp v26, v26, v26 quad_perm:[1,0,3,2] row_mask:0xf bank_mask:0xf
v_add_f32_dpp v27, v27, v27 quad_perm:[1,0,3,2] row_mask:0xf bank_mask:0xf
v_add_f32_dpp v28, v28, v28 quad_perm:[1,0,3,2] row_mask:0xf bank_mask:0xf
v_add_f32_dpp v29, v29, v29 quad_perm:[1,0,3,2] row_mask:0xf bank_mask:0xf
v_add_f32_dpp v30, v30, v30 quad_perm:[1,0,3,2] row_mask:0xf bank_mask:0xf
v_add_f32_dpp v31, v31, v31 quad_perm:[1,0,3,2] row_mask:0xf bank_mask:0xf
v_add_f32_dpp v24, v24, v24 quad_perm:[2,3,0,1] row_mask:0xf bank_mask:0xf
v_add_f32_dpp v25, v25, v25 quad_perm:[2,3,0,1] row_mask:0xf bank_mask:0xf
v_add_f32_dpp v26, v26, v26 quad_perm:[2,3,0,1] row_mask:0xf bank_mask:0xf
v_add_f32_dpp v27, v27, v27 quad_perm:[2,3,0,1] row_mask:0xf bank_mask:0xf
v_add_f32_dpp v28, v28, v28 quad_perm:[2,3,0,1] row_mask:0xf bank_mask:0xf
v_add_f32_dpp v29, v29, v29 quad_perm:[2,3,0,1] row_mask:0xf bank_mask:0xf
v_add_f32_dpp v30, v30, v30 quad_perm:[2,3,0,1] row_mask:0xf bank_mask:0xf
v_add_f32_dpp v31, v31, v31 quad_perm:[2,3,0,1] row_mask:0xf bank_mask:0xf
v_add_f32_dpp v24, v24, v24 row_half_mirror row_mask:0xf bank_mask:0xf
v_add_f32_dpp v25, v25, v25 row_half_mirror row_mask:0xf bank_mask:0xf
v_add_f32_dpp v26, v26, v26 row_half_mirror row_mask:0xf bank_mask:0xf
v_add_f32_dpp v27, v27, v27 row_half_mirror row_mask:0xf bank_mask:0xf
v_add_f32_dpp v28, v28, v28 row_half_mirror row_mask:0xf bank_mask:0xf
v_add_f32_dpp v29, v29, v29 row_half_mirror row_mask:0xf bank_mask:0xf
v_add_f32_dpp v30, v30, v30 row_half_mirror row_mask:0xf bank_mask:0xf
v_add_f32_dpp v31, v31, v31 row_half_mirror row_mask:0xf bank_mask:0xf
v_cvt_pk_bf16_f32 v24, v24, v25
v_cvt_pk_bf16_f32 v25, v26, v27
v_cvt_pk_bf16_f32 v26, v28, v29
v_cvt_pk_bf16_f32 v27, v30, v31
s_mov_b32 exec_lo, 0x01010101
s_mov_b32 exec_hi, 0x01010101
ds_write_b64 v98, v[24:25]
ds_write_b64 v98, v[26:27] offset:64
s_mov_b64 exec, -1
ds_read_b128 v[32:35], v99
ds_read_b128 v[36:39], v99 offset:64
s_cmp_lg_u32 s46, 0
s_cbranch_scc1 L_wo2_77
s_mov_b32 s77, 0
v_mov_b32 v3, 163008
L_lw_78:
ds_read_b32 v2, v3
s_waitcnt lgkmcnt(0)
v_readfirstlane_b32 s11, v2
s_nop 0
s_cmp_ge_u32 s11, 7
s_cbranch_scc1 L_lwd_80
s_add_u32 s77, s77, 1
s_cmp_lt_u32 s77, 1600000
s_cbranch_scc1 L_lw_78
L_lwd_80:
ds_read_b64_tr_b16 v[52:53], v96 offset:0
ds_read_b64_tr_b16 v[54:55], v96 offset:256
ds_read_b64_tr_b16 v[60:61], v97 offset:0
ds_read_b64_tr_b16 v[62:63], v97 offset:256
ds_read_b64_tr_b16 v[56:57], v96 offset:2048
ds_read_b64_tr_b16 v[58:59], v96 offset:2304
ds_read_b64_tr_b16 v[64:65], v97 offset:2048
ds_read_b64_tr_b16 v[66:67], v97 offset:2304
L_wo2_77:
s_waitcnt lgkmcnt(0)
v_mfma_f32_16x16x32_bf16 v[40:43], v[52:55], v[32:35], 0
v_mfma_f32_16x16x32_bf16 v[44:47], v[60:63], v[32:35], 0
v_mfma_f32_16x16x32_bf16 v[40:43], v[56:59], v[36:39], v[40:43]
v_mfma_f32_16x16x32_bf16 v[44:47], v[64:67], v[36:39], v[44:47]
s_mov_b32 exec_lo, 0x00010001
s_mov_b32 exec_hi, 0x00010001
s_nop 4
ds_write_b128 v130, v[40:43]
ds_write_b128 v130, v[44:47] offset:64
s_mov_b64 exec, -1
s_waitcnt lgkmcnt(0)
s_barrier
s_cmp_lg_u32 s8, 0
s_cbranch_scc1 L_final
ds_read_b128 v[20:23], v131
v_mov_b32 v48, 163040
ds_read_b32 v48, v48
s_waitcnt lgkmcnt(0)
v_add_f32_dpp v20, v20, v20 quad_perm:[1,0,3,2] row_mask:0xf bank_mask:0xf
v_add_f32_dpp v21, v21, v21 quad_perm:[1,0,3,2] row_mask:0xf bank_mask:0xf
v_add_f32_dpp v22, v22, v22 quad_perm:[1,0,3,2] row_mask:0xf bank_mask:0xf
v_add_f32_dpp v23, v23, v23 quad_perm:[1,0,3,2] row_mask:0xf bank_mask:0xf
v_add_f32_dpp v20, v20, v20 quad_perm:[2,3,0,1] row_mask:0xf bank_mask:0xf
v_add_f32_dpp v21, v21, v21 quad_perm:[2,3,0,1] row_mask:0xf bank_mask:0xf
v_add_f32_dpp v22, v22, v22 quad_perm:[2,3,0,1] row_mask:0xf bank_mask:0xf
v_add_f32_dpp v23, v23, v23 quad_perm:[2,3,0,1] row_mask:0xf bank_mask:0xf
v_add_f32_dpp v20, v20, v20 row_half_mirror row_mask:0xf bank_mask:0xf
v_add_f32_dpp v21, v21, v21 row_half_mirror row_mask:0xf bank_mask:0xf
v_add_f32_dpp v22, v22, v22 row_half_mirror row_mask:0xf bank_mask:0xf
v_add_f32_dpp v23, v23, v23 row_half_mirror row_mask:0xf bank_mask:0xf
v_bfi_b32 v20, v1, s68, v20
v_bfi_b32 v21, v1, s69, v21
v_bfi_b32 v22, v1, s70, v22
v_bfi_b32 v23, v1, s71, v23
buffer_store_dwordx4 v[20:23], v132, s[48:51], s82 offen sc1
v_lshlrev_b32 v36, 16, v140
v_and_b32 v37, 0xffff0000, v140
v_lshlrev_b32 v38, 16, v141
v_and_b32 v39, 0xffff0000, v141
buffer_load_dwordx4 v[28:31], v138, s[48:51], 0 offen sc1
buffer_load_dwordx4 v[24:27], v137, s[48:51], 0 offen sc1
s_waitcnt vmcnt(1)
v_perm_b32 v14, v29, v28, s72
v_perm_b32 v15, v31, v30, s73
v_or_b32 v14, v14, v15
v_cmp_ne_u32 s[78:79], s9, v14
s_nop 0
s_cmp_lg_u64 s[78:79], 0
s_cbranch_scc0 L_mrok_81
s_mov_b32 s75, 0
s_mov_b32 s76, 0
s_mov_b32 s77, 0
s_mov_b64 s[98:99], exec
L_poll_83:
buffer_load_dwordx4 v[28:31], v138, s[48:51], 0 offen sc1
s_waitcnt vmcnt(0)
v_perm_b32 v14, v29, v28, s72
v_perm_b32 v15, v31, v30, s73
v_or_b32 v14, v14, v15
v_cmp_ne_u32 s[78:79], s9, v14
s_nop 0
s_cmp_lg_u64 s[78:79], 0
s_cbranch_scc0 L_pdone_84
s_mov_b64 exec, s[78:79]
s_add_u32 s76, s76, 1
s_cmp_eq_u32 s76, 96
s_cbranch_scc1 L_pswitch_85
s_cmp_lt_u32 s76, 200000
s_cbranch_scc1 L_poll_83
L_pdone_84:
s_mov_b64 exec, s[98:99]
L_mrok_81:
s_nop 0
v_add_f32_dpp v28, v28, v28 quad_perm:[1,0,3,2] row_mask:0xf bank_mask:0xf
v_add_f32_dpp v29, v29, v29 quad_perm:[1,0,3,2] row_mask:0xf bank_mask:0xf
v_add_f32_dpp v30, v30, v30 quad_perm:[1,0,3,2] row_mask:0xf bank_mask:0xf
v_add_f32_dpp v31, v31, v31 quad_perm:[1,0,3,2] row_mask:0xf bank_mask:0xf
v_cvt_pk_bf16_f32 v14, v28, v29
v_lshlrev_b32 v28, 16, v14
v_and_b32 v29, 0xffff0000, v14
v_cvt_pk_bf16_f32 v15, v30, v31
v_lshlrev_b32 v30, 16, v15
v_and_b32 v31, 0xffff0000, v15
v_add_f32 v32, 1.0, v28
v_add_f32 v33, 1.0, v29
v_add_f32 v34, 1.0, v30
v_add_f32 v35, 1.0, v31
v_cvt_pk_bf16_f32 v14, v32, v33
v_lshlrev_b32 v32, 16, v14
v_and_b32 v33, 0xffff0000, v14
v_cvt_pk_bf16_f32 v15, v34, v35
v_lshlrev_b32 v34, 16, v15
v_and_b32 v35, 0xffff0000, v15
v_bfi_b32 v140, v1, s68, v28
v_bfi_b32 v141, v1, s69, v29
v_bfi_b32 v142, v1, s70, v30
v_bfi_b32 v143, v1, s71, v31
s_mov_b32 exec_lo, 0x10101010
s_mov_b32 exec_hi, 0x10101010
v_bfi_b32 v140, v1, s68, v32
v_bfi_b32 v141, v1, s69, v33
v_bfi_b32 v142, v1, s70, v34
v_bfi_b32 v143, v1, s71, v35
s_mov_b64 exec, -1
s_waitcnt vmcnt(0)
v_perm_b32 v14, v25, v24, s72
v_perm_b32 v15, v27, v26, s73
v_or_b32 v14, v14, v15
v_cmp_ne_u32 s[78:79], s9, v14
s_nop 0
s_cmp_lg_u64 s[78:79], 0
s_cbranch_scc0 L_wpok_82
s_mov_b32 s75, 0
s_mov_b32 s76, 0
s_mov_b32 s77, 0
s_mov_b64 s[98:99], exec
L_poll_88:
buffer_load_dwordx4 v[24:27], v137, s[48:51], 0 offen sc1
s_waitcnt vmcnt(0)
v_perm_b32 v14, v25, v24, s72
v_perm_b32 v15, v27, v26, s73
v_or_b32 v14, v14, v15
v_cmp_ne_u32 s[78:79], s9, v14
s_nop 0
s_cmp_lg_u64 s[78:79], 0
s_cbranch_scc0 L_pdone_89
s_mov_b64 exec, s[78:79]
s_add_u32 s76, s76, 1
s_cmp_eq_u32 s76, 96
s_cbranch_scc1 L_pswitch_90
s_cmp_lt_u32 s76, 200000
s_cbranch_scc1 L_poll_88
L_pdone_89:
s_mov_b64 exec, s[98:99]
L_wpok_82:
s_nop 0
v_add_f32_dpp v24, v24, v24 quad_perm:[1,0,3,2] row_mask:0xf bank_mask:0xf
v_add_f32_dpp v25, v25, v25 quad_perm:[1,0,3,2] row_mask:0xf bank_mask:0xf
v_add_f32_dpp v26, v26, v26 quad_perm:[1,0,3,2] row_mask:0xf bank_mask:0xf
v_add_f32_dpp v27, v27, v27 quad_perm:[1,0,3,2] row_mask:0xf bank_mask:0xf
v_add_f32_dpp v24, v24, v24 quad_perm:[2,3,0,1] row_mask:0xf bank_mask:0xf
v_add_f32_dpp v25, v25, v25 quad_perm:[2,3,0,1] row_mask:0xf bank_mask:0xf
v_add_f32_dpp v26, v26, v26 quad_perm:[2,3,0,1] row_mask:0xf bank_mask:0xf
v_add_f32_dpp v27, v27, v27 quad_perm:[2,3,0,1] row_mask:0xf bank_mask:0xf
v_add_f32_dpp v24, v24, v24 row_half_mirror row_mask:0xf bank_mask:0xf
v_add_f32_dpp v25, v25, v25 row_half_mirror row_mask:0xf bank_mask:0xf
v_add_f32_dpp v26, v26, v26 row_half_mirror row_mask:0xf bank_mask:0xf
v_add_f32_dpp v27, v27, v27 row_half_mirror row_mask:0xf bank_mask:0xf
v_cvt_pk_bf16_f32 v14, v24, v25
v_lshlrev_b32 v24, 16, v14
v_and_b32 v25, 0xffff0000, v14
v_cvt_pk_bf16_f32 v15, v26, v27
v_lshlrev_b32 v26, 16, v15
v_and_b32 v27, 0xffff0000, v15
v_pk_mul_f32 v[24:25], v[28:29], v[24:25]
v_pk_mul_f32 v[26:27], v[30:31], v[26:27]
v_cvt_pk_bf16_f32 v14, v24, v25
v_lshlrev_b32 v24, 16, v14
v_and_b32 v25, 0xffff0000, v14
v_cvt_pk_bf16_f32 v15, v26, v27
v_lshlrev_b32 v26, 16, v15
v_and_b32 v27, 0xffff0000, v15
v_pk_add_f32 v[24:25], v[36:37], v[24:25]
v_pk_add_f32 v[26:27], v[38:39], v[26:27]
v_cvt_pk_bf16_f32 v14, v24, v25
v_lshlrev_b32 v24, 16, v14
v_and_b32 v25, 0xffff0000, v14
v_cvt_pk_bf16_f32 v15, v26, v27
v_lshlrev_b32 v26, 16, v15
v_and_b32 v27, 0xffff0000, v15
s_mov_b32 exec_lo, 0x01010101
s_mov_b32 exec_hi, 0x01010101
v_bfi_b32 v140, v1, s68, v24
v_bfi_b32 v141, v1, s69, v25
v_bfi_b32 v142, v1, s70, v26
v_bfi_b32 v143, v1, s71, v27
s_mov_b32 exec_lo, 0x55555555
s_mov_b32 exec_hi, 0x55555555
buffer_store_dwordx4 v[140:143], v139, s[48:51], 0 offen
s_mov_b64 s[94:95], exec
v_readfirstlane_b32 s11, v48
s_nop 0
s_cmp_eq_u32 s11, 0
s_cbranch_scc1 L_fb_93
s_mov_b64 exec, s[94:95]
s_cbranch_execz L_bx_94
s_mov_b32 s11, 393216
buffer_store_dwordx4 v[140:143], v139, s[48:51], s11 offen sc1
L_bx_94:
L_fb_93:
s_mov_b64 exec, -1
s_branch L_final
L_notW:
s_mov_b32 s75, 0
s_mov_b32 s76, 0
s_mov_b32 s77, 0
s_mov_b64 s[98:99], exec
L_poll_95:
buffer_load_dwordx4 v[36:39], v155, s[48:51], s75 offen sc1
s_waitcnt vmcnt(0)
v_perm_b32 v14, v37, v36, s72
v_perm_b32 v15, v39, v38, s73
v_or_b32 v14, v14, v15
v_cmp_ne_u32 s[78:79], s9, v14
s_nop 0
s_cmp_lg_u64 s[78:79], 0
s_cbranch_scc0 L_pdone_96
s_mov_b64 exec, s[78:79]
s_xor_b32 s75, s75, s77
s_add_u32 s76, s76, 1
s_sleep 2
s_cmp_eq_u32 s76, 96
s_cbranch_scc1 L_pswitch_97
s_cmp_lt_u32 s76, 200000
s_cbranch_scc1 L_poll_95
L_pdone_96:
s_mov_b64 exec, s[98:99]
v_and_b32 v38, 0xffffff00, v38
v_cmp_ne_u32 s[78:79], s90, v38
s_nop 0
s_cmp_lg_u64 s[78:79], 0
s_cbranch_scc1 L_fo_100
L_fog_101:
s_cmp_ge_u32 s5, 30
s_cbranch_scc1 L_final
s_mov_b32 s77, 0
v_mov_b32 v3, 163008
L_lw_104:
ds_read_b32 v2, v3
s_waitcnt lgkmcnt(0)
v_readfirstlane_b32 s11, v2
s_nop 0
s_cmp_ge_u32 s11, 7
s_cbranch_scc1 L_lwd_106
s_add_u32 s77, s77, 1
s_cmp_lt_u32 s77, 1600000
s_cbranch_scc1 L_lw_104
L_lwd_106:
s_cmp_ge_u32 s8, 5
s_cbranch_scc1 L_mr_join
s_lshl_b32 s11, s8, 7
s_add_u32 s11, s11, 163136
v_lshlrev_b32 v2, 4, v156
v_add_u32 v2, s11, v2
ds_read_b128 v[32:35], v2
ds_read_b128 v[36:39], v2 offset:64
v_lshrrev_b32 v6, 1, v158
v_and_b32 v7, 1, v156
v_lshl_or_b32 v6, v7, 1, v6
v_lshlrev_b32 v6, 1, v6
v_lshrrev_b32 v7, 1, v159
v_xor_b32 v6, v6, v7
v_lshlrev_b32 v6, 4, v6
v_and_b32 v7, 1, v159
v_lshl_add_u32 v6, v7, 3, v6
v_lshl_add_u32 v7, v156, 3, v158
v_lshl_add_u32 v6, v7, 7, v6
s_lshl_b32 s11, s8, 13
v_add_u32 v6, s11, v6
ds_read_b64_tr_b16 v[52:53], v6 offset:0
ds_read_b64_tr_b16 v[54:55], v6 offset:512
ds_read_b64_tr_b16 v[56:57], v6 offset:4096
ds_read_b64_tr_b16 v[58:59], v6 offset:4608
v_xor_b32 v7, 32, v6
ds_read_b64_tr_b16 v[60:61], v7 offset:0
ds_read_b64_tr_b16 v[62:63], v7 offset:512
ds_read_b64_tr_b16 v[64:65], v7 offset:4096
ds_read_b64_tr_b16 v[66:67], v7 offset:4608
v_xor_b32 v7, 64, v6
ds_read_b64_tr_b16 v[68:69], v7 offset:0
ds_read_b64_tr_b16 v[70:71], v7 offset:512
ds_read_b64_tr_b16 v[72:73], v7 offset:4096
ds_read_b64_tr_b16 v[74:75], v7 offset:4608
v_xor_b32 v7, 96, v6
ds_read_b64_tr_b16 v[76:77], v7 offset:0
ds_read_b64_tr_b16 v[78:79], v7 offset:512
ds_read_b64_tr_b16 v[80:81], v7 offset:4096
ds_read_b64_tr_b16 v[82:83], v7 offset:4608
s_waitcnt lgkmcnt(12)
v_mfma_f32_16x16x32_bf16 v[100:103], v[52:55], v[32:35], 0
v_mfma_f32_16x16x32_bf16 v[100:103], v[56:59], v[36:39], v[100:103]
s_waitcnt lgkmcnt(8)
v_mfma_f32_16x16x32_bf16 v[104:107], v[60:63], v[32:35], 0
v_mfma_f32_16x16x32_bf16 v[104:107], v[64:67], v[36:39], v[104:107]
s_waitcnt lgkmcnt(4)
v_mfma_f32_16x16x32_bf16 v[108:111], v[68:71], v[32:35], 0
v_mfma_f32_16x16x32_bf16 v[108:111], v[72:75], v[36:39], v[108:111]
s_waitcnt lgkmcnt(0)
v_mfma_f32_16x16x32_bf16 v[40:43], v[76:79], v[32:35], 0
v_mfma_f32_16x16x32_bf16 v[40:43], v[80:83], v[36:39], v[40:43]
v_lshlrev_b32 v2, 4, v156
s_lshl_b32 s11, s8, 8
s_add_u32 s11, s11, 133120
v_add_u32 v2, s11, v2
s_mov_b32 exec_lo, 0x00010001
s_mov_b32 exec_hi, 0x00010001
ds_write_b128 v2, v[100:103] offset:0
ds_write_b128 v2, v[104:107] offset:64
ds_write_b128 v2, v[108:111] offset:128
ds_write_b128 v2, v[40:43] offset:192
s_mov_b64 exec, -1
L_mr_join:
s_waitcnt lgkmcnt(0)
s_barrier
s_cmp_lg_u32 s8, 0
s_cbranch_scc1 L_final
v_lshlrev_b32 v3, 4, v157
v_add_u32 v2, 133120, v3
ds_read_b128 v[20:23], v2 offset:0
ds_read_b128 v[24:27], v2 offset:256
ds_read_b128 v[28:31], v2 offset:512
ds_read_b128 v[32:35], v2 offset:768
ds_read_b128 v[36:39], v2 offset:1024
v_mul_u32_u24 v4, 20480, v156
v_add_u32 v3, v3, v4
s_sub_u32 s12, s5, 20
s_lshl_b32 s12, s12, 3
s_add_u32 s12, s12, s4
s_and_b32 s14, s12, 1
s_lshr_b32 s12, s12, 1
s_mul_i32 s11, s14, 10240
s_lshl_b32 s12, s12, 8
s_add_u32 s11, s11, s12
s_add_u32 s11, s11, 1245184
s_add_u32 s12, s11, 81920
s_waitcnt lgkmcnt(0)
v_pk_add_f32 v[20:21], v[20:21], v[24:25]
v_pk_add_f32 v[22:23], v[22:23], v[26:27]
v_pk_add_f32 v[20:21], v[20:21], v[28:29]
v_pk_add_f32 v[22:23], v[22:23], v[30:31]
v_pk_add_f32 v[20:21], v[20:21], v[32:33]
v_pk_add_f32 v[22:23], v[22:23], v[34:35]
v_pk_add_f32 v[20:21], v[20:21], v[36:37]
v_pk_add_f32 v[22:23], v[22:23], v[38:39]
v_bfi_b32 v20, v1, s68, v20
v_bfi_b32 v21, v1, s69, v21
v_bfi_b32 v22, v1, s70, v22
v_bfi_b32 v23, v1, s71, v23
buffer_store_dwordx4 v[20:23], v3, s[48:51], s11 offen sc1
buffer_store_dwordx4 v[20:23], v3, s[48:51], s12 offen sc1
s_branch L_final
L_final:
s_cmp_ge_u32 s8, 3
s_cbranch_scc1 L_ln_idle
s_mov_b32 s75, 0
s_mov_b32 s76, 0
s_mov_b32 s77, 0
s_mov_b64 s[98:99], exec
L_poll_107:
buffer_load_dwordx4 v[20:23], v133, s[48:51], s75 offen sc1
buffer_load_dwordx4 v[24:27], v133, s[48:51], s75 offen offset:2560 sc1
buffer_load_dwordx4 v[28:31], v148, s[48:51], s75 offen sc1
buffer_load_dwordx4 v[32:35], v148, s[48:51], s75 offen offset:2560 sc1
s_waitcnt vmcnt(0)
v_perm_b32 v14, v21, v20, s72
v_perm_b32 v15, v23, v22, s73
v_or_b32 v14, v14, v15
v_cmp_ne_u32 s[78:79], s9, v14
v_perm_b32 v14, v25, v24, s72
v_perm_b32 v15, v27, v26, s73
v_or_b32 v14, v14, v15
v_cmp_ne_u32 vcc, s9, v14
s_nop 0
s_or_b64 s[78:79], s[78:79], vcc
v_perm_b32 v14, v29, v28, s72
v_perm_b32 v15, v31, v30, s73
v_or_b32 v14, v14, v15
v_cmp_ne_u32 vcc, s9, v14
s_nop 0
s_or_b64 s[78:79], s[78:79], vcc
v_perm_b32 v14, v33, v32, s72
v_perm_b32 v15, v35, v34, s73
v_or_b32 v14, v14, v15
v_cmp_ne_u32 vcc, s9, v14
s_nop 0
s_or_b64 s[78:79], s[78:79], vcc
s_cmp_lg_u64 s[78:79], 0
s_cbranch_scc0 L_pdone_108
s_mov_b64 exec, s[78:79]
s_xor_b32 s75, s75, s77
s_add_u32 s76, s76, 1
s_sleep 1
s_cmp_eq_u32 s76, 96
s_cbranch_scc1 L_pswitch_109
s_cmp_lt_u32 s76, 200000
s_cbranch_scc1 L_poll_107
L_pdone_108:
s_mov_b64 exec, s[98:99]
v_perm_b32 v52, v21, v20, s83
v_perm_b32 v53, v23, v22, s83
v_and_b32 v100, 0xffff0000, v20
v_and_b32 v101, 0xffff0000, v21
v_and_b32 v102, 0xffff0000, v22
v_and_b32 v103, 0xffff0000, v23
v_perm_b32 v54, v33, v32, s83
v_perm_b32 v55, v35, v34, s83
v_and_b32 v104, 0xffff0000, v24
v_and_b32 v105, 0xffff0000, v25
v_and_b32 v106, 0xffff0000, v26
v_and_b32 v107, 0xffff0000, v27
v_and_b32 v108, 0xffff0000, v28
v_and_b32 v109, 0xffff0000, v29
v_and_b32 v110, 0xffff0000, v30
v_and_b32 v111, 0xffff0000, v31
v_pk_add_f32 v[88:89], v[100:101], v[102:103]
v_pk_mul_f32 v[90:91], v[100:101], v[100:101]
v_pk_fma_f32 v[90:91], v[102:103], v[102:103], v[90:91]
v_add_f32 v88, v88, v89
v_add_f32 v89, v90, v91
v_cndmask_b32 v88, 0, v88, s[80:81]
v_cndmask_b32 v89, 0, v89, s[80:81]
s_mov_b64 exec, s[80:81]
ds_write_b64 v146, v[52:53]
ds_write_b64 v146, v[54:55] offset:2560
s_mov_b64 exec, -1
s_nop 0
v_add_f32_dpp v88, v88, v88 quad_perm:[1,0,3,2] row_mask:0xf bank_mask:0xf
v_add_f32_dpp v89, v89, v89 quad_perm:[1,0,3,2] row_mask:0xf bank_mask:0xf
s_nop 0
v_add_f32_dpp v88, v88, v88 quad_perm:[2,3,0,1] row_mask:0xf bank_mask:0xf
v_add_f32_dpp v89, v89, v89 quad_perm:[2,3,0,1] row_mask:0xf bank_mask:0xf
s_nop 0
v_add_f32_dpp v88, v88, v88 row_half_mirror row_mask:0xf bank_mask:0xf
v_add_f32_dpp v89, v89, v89 row_half_mirror row_mask:0xf bank_mask:0xf
s_nop 0
v_add_f32_dpp v88, v88, v88 row_mirror row_mask:0xf bank_mask:0xf
v_add_f32_dpp v89, v89, v89 row_mirror row_mask:0xf bank_mask:0xf
s_nop 0
v_add_f32_dpp v88, v88, v88 row_bcast:15 row_mask:0xa bank_mask:0xf
v_add_f32_dpp v89, v89, v89 row_bcast:15 row_mask:0xa bank_mask:0xf
s_nop 0
v_add_f32_dpp v88, v88, v88 row_bcast:31 row_mask:0xc bank_mask:0xf
v_add_f32_dpp v89, v89, v89 row_bcast:31 row_mask:0xc bank_mask:0xf
s_mov_b32 exec_lo, 0x00000000
s_mov_b32 exec_hi, 0x80000000
ds_write_b64 v144, v[88:89] offset:0
s_mov_b64 exec, -1
s_cmp_lg_u32 s2, 0
s_cbranch_scc1 L_noep
s_cmp_lg_u32 s8, 0
s_cbranch_scc1 L_noep
s_mov_b32 exec_lo, 0x00000001
s_mov_b32 exec_hi, 0x00000000
v_mov_b32 v4, 0
v_mov_b32 v5, s9
buffer_store_dword v5, v4, s[48:51], 0 offen sc1
s_mov_b64 exec, -1
L_noep:
s_waitcnt lgkmcnt(0)
s_barrier
ds_read_b128 v[94:97], v145 offset:0
ds_read_b64 v[98:99], v145 offset:16
s_waitcnt lgkmcnt(0)
v_pk_add_f32 v[94:95], v[94:95], v[96:97]
v_pk_add_f32 v[94:95], v[94:95], v[98:99]
v_mul_f32 v91, 0x3acccccd, v94
v_mul_f32 v92, 0x3acccccd, v95
v_fma_f32 v92, -v91, v91, v92
v_max_f32 v92, 0, v92
v_cvt_pk_bf16_f32 v93, v91, v92
v_lshlrev_b32 v91, 16, v93
v_and_b32 v92, 0xffff0000, v93
v_add_f32 v92, 0x3727c5ac, v92
v_cvt_pk_bf16_f32 v92, v92, v92
v_lshlrev_b32 v92, 16, v92
v_sqrt_f32 v92, v92
s_nop 0
v_cvt_pk_bf16_f32 v92, v92, v92
v_lshlrev_b32 v92, 16, v92
v_rcp_f32 v92, v92
v_pk_add_f32 v[100:101], v[100:101], v[90:91] op_sel:[0,1] op_sel_hi:[1,1] neg_lo:[0,1] neg_hi:[0,1]
v_pk_add_f32 v[102:103], v[102:103], v[90:91] op_sel:[0,1] op_sel_hi:[1,1] neg_lo:[0,1] neg_hi:[0,1]
v_cvt_pk_bf16_f32 v84, v100, v101
v_cvt_pk_bf16_f32 v85, v102, v103
v_lshlrev_b32 v100, 16, v84
v_and_b32 v101, 0xffff0000, v84
v_lshlrev_b32 v102, 16, v85
v_and_b32 v103, 0xffff0000, v85
v_pk_mul_f32 v[100:101], v[100:101], v[92:93] op_sel_hi:[1,0]
v_pk_mul_f32 v[102:103], v[102:103], v[92:93] op_sel_hi:[1,0]
v_cvt_pk_bf16_f32 v84, v100, v101
v_cvt_pk_bf16_f32 v85, v102, v103
v_lshlrev_b32 v100, 16, v84
v_and_b32 v101, 0xffff0000, v84
v_lshlrev_b32 v102, 16, v85
v_and_b32 v103, 0xffff0000, v85
v_pk_mul_f32 v[100:101], v[100:101], v[108:109]
v_pk_mul_f32 v[102:103], v[102:103], v[110:111]
v_cvt_pk_bf16_f32 v84, v100, v101
v_cvt_pk_bf16_f32 v85, v102, v103
v_lshlrev_b32 v100, 16, v84
v_and_b32 v101, 0xffff0000, v84
v_lshlrev_b32 v102, 16, v85
v_and_b32 v103, 0xffff0000, v85
v_pk_add_f32 v[100:101], v[100:101], v[104:105]
v_pk_add_f32 v[102:103], v[102:103], v[106:107]
v_cvt_pk_bf16_f32 v84, v100, v101
v_cvt_pk_bf16_f32 v85, v102, v103
v_lshlrev_b32 v100, 16, v84
v_and_b32 v101, 0xffff0000, v84
v_lshlrev_b32 v102, 16, v85
v_and_b32 v103, 0xffff0000, v85
v_pk_add_f32 v[88:89], v[100:101], v[102:103]
v_pk_mul_f32 v[90:91], v[100:101], v[100:101]
v_pk_fma_f32 v[90:91], v[102:103], v[102:103], v[90:91]
v_add_f32 v88, v88, v89
v_add_f32 v89, v90, v91
v_cndmask_b32 v88, 0, v88, s[80:81]
v_cndmask_b32 v89, 0, v89, s[80:81]
s_mov_b64 exec, s[80:81]
ds_write_b64 v146, v[84:85] offset:1280
s_mov_b64 exec, -1
s_nop 0
v_add_f32_dpp v88, v88, v88 quad_perm:[1,0,3,2] row_mask:0xf bank_mask:0xf
v_add_f32_dpp v89, v89, v89 quad_perm:[1,0,3,2] row_mask:0xf bank_mask:0xf
s_nop 0
v_add_f32_dpp v88, v88, v88 quad_perm:[2,3,0,1] row_mask:0xf bank_mask:0xf
v_add_f32_dpp v89, v89, v89 quad_perm:[2,3,0,1] row_mask:0xf bank_mask:0xf
s_nop 0
v_add_f32_dpp v88, v88, v88 row_half_mirror row_mask:0xf bank_mask:0xf
v_add_f32_dpp v89, v89, v89 row_half_mirror row_mask:0xf bank_mask:0xf
s_nop 0
v_add_f32_dpp v88, v88, v88 row_mirror row_mask:0xf bank_mask:0xf
v_add_f32_dpp v89, v89, v89 row_mirror row_mask:0xf bank_mask:0xf
s_nop 0
v_add_f32_dpp v88, v88, v88 row_bcast:15 row_mask:0xa bank_mask:0xf
v_add_f32_dpp v89, v89, v89 row_bcast:15 row_mask:0xa bank_mask:0xf
s_nop 0
v_add_f32_dpp v88, v88, v88 row_bcast:31 row_mask:0xc bank_mask:0xf
v_add_f32_dpp v89, v89, v89 row_bcast:31 row_mask:0xc bank_mask:0xf
s_mov_b32 exec_lo, 0x00000000
s_mov_b32 exec_hi, 0x80000000
ds_write_b64 v144, v[88:89] offset:64
s_mov_b64 exec, -1
s_waitcnt lgkmcnt(0)
s_barrier
s_branch L_ln_fin
L_ln_idle:
s_barrier
s_barrier
L_ln_fin:
ds_read_b128 v[94:97], v145 offset:64
ds_read_b64 v[98:99], v145 offset:80
ds_read_u16 v20, v147 offset:1280
ds_read_u16 v21, v147
ds_read_u16 v22, v147 offset:2560
s_waitcnt lgkmcnt(0)
v_pk_add_f32 v[94:95], v[94:95], v[96:97]
v_pk_add_f32 v[94:95], v[94:95], v[98:99]
v_mul_f32 v91, 0x3acccccd, v94
v_mul_f32 v92, 0x3acccccd, v95
v_fma_f32 v92, -v91, v91, v92
v_max_f32 v92, 0, v92
v_cvt_pk_bf16_f32 v93, v91, v92
v_lshlrev_b32 v91, 16, v93
v_and_b32 v92, 0xffff0000, v93
v_add_f32 v92, 0x3727c5ac, v92
v_cvt_pk_bf16_f32 v92, v92, v92
v_lshlrev_b32 v92, 16, v92
v_sqrt_f32 v92, v92
s_nop 0
v_cvt_pk_bf16_f32 v92, v92, v92
v_lshlrev_b32 v92, 16, v92
v_rcp_f32 v92, v92
v_lshlrev_b32 v20, 16, v20
v_lshlrev_b32 v21, 16, v21
v_lshlrev_b32 v22, 16, v22
v_sub_f32 v20, v20, v91
v_cvt_pk_bf16_f32 v20, v20, v20
v_lshlrev_b32 v20, 16, v20
v_mul_f32 v20, v20, v92
v_cvt_pk_bf16_f32 v20, v20, v20
v_lshlrev_b32 v20, 16, v20
s_nop 0
v_readlane_b32 s88, v20, 0
v_readlane_b32 s89, v20, 1
v_readlane_b32 s90, v20, 2
v_fma_f32 v30, s88, v112, v116
v_fma_f32 v31, s88, v113, v117
v_fma_f32 v32, s88, v114, v118
v_fma_f32 v33, s88, v115, v119
v_mul_f32 v34, v30, v30
v_mul_f32 v35, v31, v31
v_mul_f32 v36, v32, v32
v_mul_f32 v37, v33, v33
v_fma_f32 v34, v34, s91, v129
v_fma_f32 v35, v35, s91, v129
v_fma_f32 v36, v36, s91, v129
v_fma_f32 v37, v37, s91, v129
v_mul_f32 v34, v34, v30
v_mul_f32 v35, v35, v31
v_mul_f32 v36, v36, v32
v_mul_f32 v37, v37, v33
v_exp_f32 v34, v34
v_exp_f32 v35, v35
v_exp_f32 v36, v36
v_exp_f32 v37, v37
v_mul_f32 v30, v30, v120
v_mul_f32 v31, v31, v121
v_mul_f32 v32, v32, v122
v_mul_f32 v33, v33, v123
v_add_f32 v34, 1.0, v34
v_add_f32 v35, 1.0, v35
v_add_f32 v36, 1.0, v36
v_add_f32 v37, 1.0, v37
v_rcp_f32 v34, v34
v_rcp_f32 v35, v35
v_rcp_f32 v36, v36
v_rcp_f32 v37, v37
v_mul_f32 v40, v30, v34
v_fmac_f32 v40, v31, v35
v_fmac_f32 v40, v32, v36
v_fmac_f32 v40, v33, v37
v_fma_f32 v30, s89, v112, v116
v_fma_f32 v31, s89, v113, v117
v_fma_f32 v32, s89, v114, v118
v_fma_f32 v33, s89, v115, v119
v_mul_f32 v34, v30, v30
v_mul_f32 v35, v31, v31
v_mul_f32 v36, v32, v32
v_mul_f32 v37, v33, v33
v_fma_f32 v34, v34, s91, v129
v_fma_f32 v35, v35, s91, v129
v_fma_f32 v36, v36, s91, v129
v_fma_f32 v37, v37, s91, v129
v_mul_f32 v34, v34, v30
v_mul_f32 v35, v35, v31
v_mul_f32 v36, v36, v32
v_mul_f32 v37, v37, v33
v_exp_f32 v34, v34
v_exp_f32 v35, v35
v_exp_f32 v36, v36
v_exp_f32 v37, v37
v_mul_f32 v30, v30, v120
v_mul_f32 v31, v31, v121
v_mul_f32 v32, v32, v122
v_mul_f32 v33, v33, v123
v_add_f32 v34, 1.0, v34
v_add_f32 v35, 1.0, v35
v_add_f32 v36, 1.0, v36
v_add_f32 v37, 1.0, v37
v_rcp_f32 v34, v34
v_rcp_f32 v35, v35
v_rcp_f32 v36, v36
v_rcp_f32 v37, v37
v_mul_f32 v41, v30, v34
v_fmac_f32 v41, v31, v35
v_fmac_f32 v41, v32, v36
v_fmac_f32 v41, v33, v37
v_mov_b32 v42, 0
s_cmp_ge_u32 s5, 16
s_cbranch_scc1 L_two
v_fma_f32 v30, s90, v112, v116
v_fma_f32 v31, s90, v113, v117
v_fma_f32 v32, s90, v114, v118
v_fma_f32 v33, s90, v115, v119
v_mul_f32 v34, v30, v30
v_mul_f32 v35, v31, v31
v_mul_f32 v36, v32, v32
v_mul_f32 v37, v33, v33
v_fma_f32 v34, v34, s91, v129
v_fma_f32 v35, v35, s91, v129
v_fma_f32 v36, v36, s91, v129
v_fma_f32 v37, v37, s91, v129
v_mul_f32 v34, v34, v30
v_mul_f32 v35, v35, v31
v_mul_f32 v36, v36, v32
v_mul_f32 v37, v37, v33
v_exp_f32 v34, v34
v_exp_f32 v35, v35
v_exp_f32 v36, v36
v_exp_f32 v37, v37
v_mul_f32 v30, v30, v120
v_mul_f32 v31, v31, v121
v_mul_f32 v32, v32, v122
v_mul_f32 v33, v33, v123
v_add_f32 v34, 1.0, v34
v_add_f32 v35, 1.0, v35
v_add_f32 v36, 1.0, v36
v_add_f32 v37, 1.0, v37
v_rcp_f32 v34, v34
v_rcp_f32 v35, v35
v_rcp_f32 v36, v36
v_rcp_f32 v37, v37
v_mul_f32 v42, v30, v34
v_fmac_f32 v42, v31, v35
v_fmac_f32 v42, v32, v36
v_fmac_f32 v42, v33, v37
L_two:
v_add_f32_dpp v40, v40, v40 quad_perm:[1,0,3,2] row_mask:0xf bank_mask:0xf
v_add_f32_dpp v41, v41, v41 quad_perm:[1,0,3,2] row_mask:0xf bank_mask:0xf
v_add_f32_dpp v42, v42, v42 quad_perm:[1,0,3,2] row_mask:0xf bank_mask:0xf
v_add_f32_dpp v40, v40, v40 quad_perm:[2,3,0,1] row_mask:0xf bank_mask:0xf
v_add_f32_dpp v41, v41, v41 quad_perm:[2,3,0,1] row_mask:0xf bank_mask:0xf
v_add_f32_dpp v42, v42, v42 quad_perm:[2,3,0,1] row_mask:0xf bank_mask:0xf
v_add_f32_dpp v40, v40, v40 row_half_mirror row_mask:0xf bank_mask:0xf
v_add_f32_dpp v41, v41, v41 row_half_mirror row_mask:0xf bank_mask:0xf
v_add_f32_dpp v42, v42, v42 row_half_mirror row_mask:0xf bank_mask:0xf
v_add_f32_dpp v40, v40, v40 row_mirror row_mask:0xf bank_mask:0xf
v_add_f32_dpp v41, v41, v41 row_mirror row_mask:0xf bank_mask:0xf
v_add_f32_dpp v42, v42, v42 row_mirror row_mask:0xf bank_mask:0xf
v_add_f32_dpp v40, v40, v40 row_bcast:15 row_mask:0xa bank_mask:0xf
v_add_f32_dpp v41, v41, v41 row_bcast:15 row_mask:0xa bank_mask:0xf
v_add_f32_dpp v42, v42, v42 row_bcast:15 row_mask:0xa bank_mask:0xf
v_add_f32_dpp v40, v40, v40 row_bcast:31 row_mask:0xc bank_mask:0xf
v_add_f32_dpp v41, v41, v41 row_bcast:31 row_mask:0xc bank_mask:0xf
v_add_f32_dpp v42, v42, v42 row_bcast:31 row_mask:0xc bank_mask:0xf
s_mov_b32 exec_lo, 0x00000000
s_mov_b32 exec_hi, 0x80000000
ds_write_b32 v134, v40
ds_write_b32 v134, v41 offset:32
ds_write_b32 v134, v42 offset:64
s_mov_b64 exec, -1
s_waitcnt lgkmcnt(0)
s_barrier
s_cmp_lg_u32 s8, 0
s_cbranch_scc1 L_fin_other
s_mov_b32 exec_lo, s74
s_mov_b32 exec_hi, 0
ds_read_b128 v[30:33], v135
ds_read_b128 v[34:37], v135 offset:16
s_waitcnt lgkmcnt(0)
v_pk_add_f32 v[30:31], v[30:31], v[32:33]
v_pk_add_f32 v[34:35], v[34:35], v[36:37]
v_pk_add_f32 v[30:31], v[30:31], v[34:35]
v_add_f32 v30, v30, v31
v_cvt_pk_bf16_f32 v30, v30, v30
v_lshlrev_b32 v30, 16, v30
v_add_f32 v30, v30, v166
v_cvt_pk_bf16_f32 v30, v30, v30
v_lshlrev_b32 v30, 16, v30
v_mul_f32 v30, v22, v30
v_cvt_pk_bf16_f32 v30, v30, v30
v_lshlrev_b32 v30, 16, v30
v_add_f32 v30, v21, v30
v_cvt_pk_bf16_f32 v30, v30, v30
buffer_store_short v30, v136, s[56:59], 0 offen
L_fin_other:
s_mov_b64 exec, -1
L_stampout:
L_end:
s_endpgm
L_ppx_38:
s_mov_b32 exec_lo, 0x00000001
s_mov_b32 exec_hi, 0x00000000
v_mov_b32 v14, 163036
v_mov_b32 v15, 1
ds_write_b32 v14, v15
s_mov_b64 exec, -1
s_mov_b32 s75, 393216
s_mov_b32 s77, 393216
s_branch L_ppb_39
L_qwb_48:
s_mov_b32 s47, 1
s_mov_b32 s13, s11
s_mov_b32 exec_lo, 0x00010001
s_mov_b32 exec_hi, 0x00010001
s_mov_b32 s11, 393216
buffer_store_dwordx4 v[124:127], v128, s[48:51], s11 offen sc1
s_mov_b64 exec, -1
s_mov_b32 s11, s13
s_branch L_qwr_49
L_pswitch_64:
s_mov_b64 s[100:101], exec
s_mov_b64 exec, s[98:99]
s_mov_b64 s[92:93], exec
s_mov_b32 exec_lo, 0x00010001
s_mov_b32 exec_hi, 0x00010001
s_mov_b32 s11, 393216
buffer_store_dwordx4 v[84:87], v92, s[48:51], s11 offen sc1
buffer_store_dwordx4 v[124:127], v128, s[48:51], s11 offen sc1
s_mov_b32 exec_lo, 0x00000001
s_mov_b32 exec_hi, 0x00000000
v_mov_b32 v14, 163040
v_mov_b32 v15, 1
ds_write_b32 v14, v15
s_cmp_lg_u32 s8, 0
s_cbranch_scc1 L_bml_65
buffer_store_dwordx4 v[150:153], v154, s[48:51], s11 offen sc1
L_bml_65:
s_mov_b64 exec, s[94:95]
s_cbranch_execz L_bx_66
s_mov_b32 s11, 393216
buffer_store_dwordx4 v[140:143], v139, s[48:51], s11 offen sc1
L_bx_66:
s_mov_b64 exec, s[92:93]
s_mov_b32 s75, 393216
s_mov_b32 s77, 393216
s_mov_b64 exec, s[100:101]
s_branch L_poll_62
L_fo_67:
s_mov_b64 s[92:93], exec
s_mov_b32 exec_lo, 0x00010001
s_mov_b32 exec_hi, 0x00010001
s_mov_b32 s11, 393216
buffer_store_dwordx4 v[84:87], v92, s[48:51], s11 offen sc1
buffer_store_dwordx4 v[124:127], v128, s[48:51], s11 offen sc1
s_mov_b32 exec_lo, 0x00000001
s_mov_b32 exec_hi, 0x00000000
v_mov_b32 v14, 163040
v_mov_b32 v15, 1
ds_write_b32 v14, v15
s_cmp_lg_u32 s8, 0
s_cbranch_scc1 L_bml_69
buffer_store_dwordx4 v[150:153], v154, s[48:51], s11 offen sc1
L_bml_69:
s_mov_b64 exec, s[94:95]
s_cbranch_execz L_bx_70
s_mov_b32 s11, 393216
buffer_store_dwordx4 v[140:143], v139, s[48:51], s11 offen sc1
L_bx_70:
s_mov_b64 exec, s[92:93]
s_branch L_fog_68
L_pswitch_74:
s_mov_b64 s[100:101], exec
s_mov_b64 exec, s[98:99]
s_mov_b64 s[92:93], exec
s_mov_b32 exec_lo, 0x00010001
s_mov_b32 exec_hi, 0x00010001
s_mov_b32 s11, 393216
buffer_store_dwordx4 v[84:87], v92, s[48:51], s11 offen sc1
buffer_store_dwordx4 v[124:127], v128, s[48:51], s11 offen sc1
s_mov_b32 exec_lo, 0x00000001
s_mov_b32 exec_hi, 0x00000000
v_mov_b32 v14, 163040
v_mov_b32 v15, 1
ds_write_b32 v14, v15
s_cmp_lg_u32 s8, 0
s_cbranch_scc1 L_bml_75
buffer_store_dwordx4 v[150:153], v154, s[48:51], s11 offen sc1
L_bml_75:
s_mov_b64 exec, s[94:95]
s_cbranch_execz L_bx_76
s_mov_b32 s11, 393216
buffer_store_dwordx4 v[140:143], v139, s[48:51], s11 offen sc1
L_bx_76:
s_mov_b64 exec, s[92:93]
s_mov_b32 s75, 393216
s_mov_b32 s77, 393216
s_mov_b64 exec, s[100:101]
s_branch L_poll_72
L_pswitch_85:
s_mov_b64 s[100:101], exec
s_mov_b64 exec, s[98:99]
s_mov_b64 s[92:93], exec
s_mov_b32 exec_lo, 0x00010001
s_mov_b32 exec_hi, 0x00010001
s_mov_b32 s11, 393216
buffer_store_dwordx4 v[84:87], v92, s[48:51], s11 offen sc1
buffer_store_dwordx4 v[124:127], v128, s[48:51], s11 offen sc1
s_mov_b32 exec_lo, 0x00000001
s_mov_b32 exec_hi, 0x00000000
v_mov_b32 v14, 163040
v_mov_b32 v15, 1
ds_write_b32 v14, v15
s_cmp_lg_u32 s8, 0
s_cbranch_scc1 L_bml_86
buffer_store_dwordx4 v[150:153], v154, s[48:51], s11 offen sc1
L_bml_86:
s_mov_b64 exec, s[94:95]
s_cbranch_execz L_bx_87
s_mov_b32 s11, 393216
buffer_store_dwordx4 v[140:143], v139, s[48:51], s11 offen sc1
L_bx_87:
s_mov_b64 exec, s[92:93]
s_mov_b64 exec, s[100:101]
s_branch L_poll_83
L_pswitch_90:
s_mov_b64 s[100:101], exec
s_mov_b64 exec, s[98:99]
s_mov_b64 s[92:93], exec
s_mov_b32 exec_lo, 0x00010001
s_mov_b32 exec_hi, 0x00010001
s_mov_b32 s11, 393216
buffer_store_dwordx4 v[84:87], v92, s[48:51], s11 offen sc1
buffer_store_dwordx4 v[124:127], v128, s[48:51], s11 offen sc1
s_mov_b32 exec_lo, 0x00000001
s_mov_b32 exec_hi, 0x00000000
v_mov_b32 v14, 163040
v_mov_b32 v15, 1
ds_write_b32 v14, v15
s_cmp_lg_u32 s8, 0
s_cbranch_scc1 L_bml_91
buffer_store_dwordx4 v[150:153], v154, s[48:51], s11 offen sc1
L_bml_91:
s_mov_b64 exec, s[94:95]
s_cbranch_execz L_bx_92
s_mov_b32 s11, 393216
buffer_store_dwordx4 v[140:143], v139, s[48:51], s11 offen sc1
L_bx_92:
s_mov_b64 exec, s[92:93]
s_mov_b64 exec, s[100:101]
s_branch L_poll_88
L_pswitch_97:
s_mov_b64 s[100:101], exec
s_mov_b64 exec, s[98:99]
s_mov_b64 s[92:93], exec
s_mov_b32 exec_lo, 0x00010001
s_mov_b32 exec_hi, 0x00010001
s_mov_b32 s11, 393216
buffer_store_dwordx4 v[84:87], v92, s[48:51], s11 offen sc1
buffer_store_dwordx4 v[124:127], v128, s[48:51], s11 offen sc1
s_mov_b32 exec_lo, 0x00000001
s_mov_b32 exec_hi, 0x00000000
v_mov_b32 v14, 163040
v_mov_b32 v15, 1
ds_write_b32 v14, v15
s_cmp_lg_u32 s8, 0
s_cbranch_scc1 L_bml_98
buffer_store_dwordx4 v[150:153], v154, s[48:51], s11 offen sc1
L_bml_98:
s_mov_b64 exec, s[94:95]
s_cbranch_execz L_bx_99
s_mov_b32 s11, 393216
buffer_store_dwordx4 v[140:143], v139, s[48:51], s11 offen sc1
L_bx_99:
s_mov_b64 exec, s[92:93]
s_mov_b32 s75, 393216
s_mov_b32 s77, 393216
s_mov_b64 exec, s[100:101]
s_branch L_poll_95
L_fo_100:
s_mov_b64 s[92:93], exec
s_mov_b32 exec_lo, 0x00010001
s_mov_b32 exec_hi, 0x00010001
s_mov_b32 s11, 393216
buffer_store_dwordx4 v[84:87], v92, s[48:51], s11 offen sc1
buffer_store_dwordx4 v[124:127], v128, s[48:51], s11 offen sc1
s_mov_b32 exec_lo, 0x00000001
s_mov_b32 exec_hi, 0x00000000
v_mov_b32 v14, 163040
v_mov_b32 v15, 1
ds_write_b32 v14, v15
s_cmp_lg_u32 s8, 0
s_cbranch_scc1 L_bml_102
buffer_store_dwordx4 v[150:153], v154, s[48:51], s11 offen sc1
L_bml_102:
s_mov_b64 exec, s[94:95]
s_cbranch_execz L_bx_103
s_mov_b32 s11, 393216
buffer_store_dwordx4 v[140:143], v139, s[48:51], s11 offen sc1
L_bx_103:
s_mov_b64 exec, s[92:93]
s_branch L_fog_101
L_pswitch_109:
s_mov_b64 s[100:101], exec
s_mov_b64 exec, s[98:99]
s_mov_b64 s[92:93], exec
s_mov_b32 exec_lo, 0x00010001
s_mov_b32 exec_hi, 0x00010001
s_mov_b32 s11, 393216
buffer_store_dwordx4 v[84:87], v92, s[48:51], s11 offen sc1
buffer_store_dwordx4 v[124:127], v128, s[48:51], s11 offen sc1
s_mov_b32 exec_lo, 0x00000001
s_mov_b32 exec_hi, 0x00000000
v_mov_b32 v14, 163040
v_mov_b32 v15, 1
ds_write_b32 v14, v15
s_cmp_lg_u32 s8, 0
s_cbranch_scc1 L_bml_110
buffer_store_dwordx4 v[150:153], v154, s[48:51], s11 offen sc1
L_bml_110:
s_mov_b64 exec, s[94:95]
s_cbranch_execz L_bx_111
s_mov_b32 s11, 393216
buffer_store_dwordx4 v[140:143], v139, s[48:51], s11 offen sc1
L_bx_111:
s_mov_b64 exec, s[92:93]
s_mov_b32 s75, 393216
s_mov_b32 s77, 393216
s_mov_b64 exec, s[100:101]
s_branch L_poll_107
L_codeend:
s_endpgm
L_padstart:
.if (L_padstart - L_pc0) < 20544
.fill (20544 - (L_padstart - L_pc0)) / 4, 4, 0xbf810000
.endif
.section .rodata,"a"
.p2align 6
.amdhsa_kernel adaLN_cond__sliding_block_cached__mixer_token_mlp__decode_kernel
  .amdhsa_next_free_vgpr 168
  .amdhsa_next_free_sgpr 102
  .amdhsa_accum_offset 168
  .amdhsa_group_segment_fixed_size 0
  .amdhsa_kernarg_size 120
  .amdhsa_user_sgpr_count 2
  .amdhsa_user_sgpr_kernarg_segment_ptr 1
  .amdhsa_system_sgpr_workgroup_id_x 1
.end_amdhsa_kernel
```
